```python
import torch

def _softmax(x, axis=-1):
    return torch.softmax(x, dim=axis)

def _gelu(x):
    return torch.nn.functional.gelu(x, approximate='tanh')

def _silu(x):
    return torch.nn.functional.silu(x)

def _sigmoid(x):
    return torch.sigmoid(x)

def _layernorm(x, axis=-1, eps=1e-05):
    m = x.mean(dim=axis, keepdim=True)
    v = x.var(dim=axis, keepdim=True, unbiased=False)
    return (x - m) / torch.sqrt(v + eps)

def _scatter_add(tgt, idx, src, axis=0):
    return tgt.clone().index_add_(axis, idx, src)

def _segment_sum(src, seg, n):
    out = torch.zeros((n,) + src.shape[1:], dtype=src.dtype)
    return out.index_add_(0, seg, src)

def _pad(x, pw):
    flat = tuple((v for pair in reversed(pw) for v in pair))
    return torch.nn.functional.pad(x, flat)
kernel_name = 'standalone__autoregressive_conv_wavernn__speech'

def setup_inputs():

    _w = lambda a: (lambda t: t.to(torch.bfloat16) if t.is_floating_point() else t)(torch.as_tensor(a))
    B, T, D, K = (2, 16000, 144, 31)
    return {'x': _w((lambda *s: torch.randn(*s, dtype=torch.bfloat16) * 0.1)(B, T, D)), 'w': _w((lambda *s: torch.randn(*s, dtype=torch.bfloat16) * 0.1)(K, D, 2 * D))}

def reference(x, w):
    B, T, D = x.shape
    K = w.shape[0]
    dil = 2
    pad = (K - 1) * dil
    xp = _pad(x, ((0, 0), (pad, 0), (0, 0)))
    h = torch.einsum('btd,de->bte', xp[:, 0:T, :], w[0])
    for i in range(1, K):
        h = h + torch.einsum('btd,de->bte', xp[:, i * dil:i * dil + T, :], w[i])
    f, g = (h[..., :D].clone(), h[..., D:].clone())
    return torch.tanh(f) * _sigmoid(g)
```

```asm
; @launch grid=(256,1,1) block=(512,1,1) lds=163840
.amdgcn_target "amdgcn-amd-amdhsa--gfx950"
.text
.globl standalone__autoregressive_conv_wavernn__speech_kernel
.p2align 8
.type standalone__autoregressive_conv_wavernn__speech_kernel,@function
standalone__autoregressive_conv_wavernn__speech_kernel:
s_cmp_ge_u32 s2, 256
s_cbranch_scc1 L_done
s_load_dwordx4 s[4:7], s[0:1], 0
s_load_dwordx4 s[20:23], s[0:1], 16
s_load_dwordx2 s[12:13], s[0:1], 32
v_lshrrev_b32 v1, 6, v0
v_and_b32 v0, 63, v0
v_readfirstlane_b32 s3, v1
s_and_b32 s32, s2, 7
s_lshr_b32 s33, s2, 3
s_nop 1
s_lshr_b32 s53, s3, 1
s_cmp_ge_u32 s32, 6
s_cselect_b32 s50, 2, 0
s_sub_u32 s33, s33, s50
s_cbranch_scc1 L_spare
s_setprio 3
s_getpc_b64 s[40:41]
L_pc:
s_lshl3_add_u32 s37, s33, s3
s_lshl_b32 s37, s37, 7
s_min_u32 s37, s37, L_done-L_pc
s_add_u32 s40, s40, s37
s_addc_u32 s41, s41, 0
v_mov_b32 v220, s40
v_mov_b32 v221, s41
global_load_dword v221, v[220:221], off
s_mul_i32 s34, s33, 57
s_lshr_b32 s34, s34, 9
s_mul_i32 s36, s34, 9
s_sub_u32 s36, s33, s36
s_lshl1_add_u32 s35, s32, s34
s_and_b32 s37, s35, 12
s_add_u32 s37, s37, s35
s_lshl2_add_u32 s37, s37, s53
s_and_b32 s38, s3, 1
s_lshl4_add_u32 s39, s38, s37
s_add_u32 s38, s32, 10
s_lshl3_add_u32 s37, s38, s3
s_cmp_lt_u32 s34, 2
s_cselect_b32 s35, s35, s38
s_cselect_b32 s39, s39, s37
s_cmp_ge_u32 s32, 6
s_cselect_b32 s37, 3, 2
s_cmp_lt_u32 s34, s37
s_cselect_b32 s18, 2571264, 0
s_cselect_b32 s59, 256, 0
s_mul_i32 s39, s39, 9
s_add_u32 s39, s39, s36
s_lshl_b32 s39, s39, 6
v_lshrrev_b32 v232, 2, v0
v_mul_u32_u24 v232, 82944, v232
v_lshrrev_b32 v233, 3, v0
v_and_b32 v233, 2, v233
v_xor_b32 v233, v233, v0
v_and_b32 v233, 3, v233
v_lshl_add_u32 v232, v233, 4, v232
v_add_u32 v232, s39, v232
v_add_u32 v233, 1326080, v232
s_lshl_b32 s44, s3, 11
s_add_u32 m0, s44, 73728
s_mov_b32 s19, 0x20000
s_waitcnt lgkmcnt(0)
s_mov_b64 s[16:17], s[6:7]
buffer_load_dwordx4 v232, s[16:19], 0 offen  lds
buffer_load_dwordx4 v233, s[16:19], 0 offen offset:1024  lds
s_sub_u32 s37, s33, 21
s_cmp_lt_u32 s37, 9
s_cselect_b32 s38, s32, 7
s_cmp_lt_u32 s38, 6
s_cselect_b32 s30, 9216000, 0
s_cmp_ge_u32 s32, 3
s_cselect_b32 s38, 221184, 0
s_lshl3_add_u32 s37, s37, s3
s_mul_i32 s37, s37, 3328
s_add_u32 s37, s37, s38
s_add_u32 s37, s37, 8792064
v_min_u32 v219, 25, v0
v_lshl_add_u32 v219, v219, 7, s37
s_mov_b64 s[28:29], s[4:5]
s_mov_b32 s31, 0x20000
buffer_load_dword v219, v219, s[28:31], 0 offen
s_setprio 2
s_mul_i32 s50, s33, 43
s_lshr_b32 s50, s50, 8
s_mul_i32 s82, s50, 6
s_sub_u32 s82, s33, s82
s_mul_i32 s51, s32, 5
s_add_u32 s51, s51, s50
s_cmp_ge_u32 s32, 3
s_cselect_b32 s37, 41, 40
s_cmp_ge_u32 s33, 30
s_cselect_b32 s51, s37, s51
s_cmp_ge_u32 s51, 21
s_cselect_b32 s37, 21, 0
s_cselect_b32 s54, 4608000, 0
s_sub_u32 s51, s51, s37
s_lshl2_add_u32 s55, s51, s53
s_lshl_b32 s37, s3, 3
s_cmp_gt_u32 s3, 4
s_cselect_b32 s38, 36, 0
s_sub_u32 s37, s37, s38
s_cmp_eq_u32 s3, 4
s_cselect_b64 s[38:39], 0, 0x3ffff
s_lshl_b64 s[38:39], s[38:39], s37
s_lshl_b64 vcc, s[38:39], 18
v_lshlrev_b32 v4, 4, v0
v_add_u32 v250, 288, v4
v_subrev_u32 v251, 288, v4
v_cndmask_b32 v240, v4, v250, s[38:39]
v_cndmask_b32 v240, v240, v251, vcc
s_lshl_b32 s57, s3, 10
s_mul_i32 s58, s51, 221184
s_add_u32 s58, s58, s57
s_add_u32 s37, s82, 0
s_and_b32 s37, s37, 3
s_mul_i32 s38, s37, 18432
s_add_u32 s84, s38, s57
s_mul_i32 s38, s37, 55296
s_add_u32 s89, s38, s58
s_mov_b32 s11, 0x20000
s_add_u32 s8, s4, s54
s_addc_u32 s9, s5, 0
s_add_u32 s80, s89, -18432
s_add_u32 m0, s84, 0
s_cmp_lt_u32 s80, 4608000
s_cselect_b32 s10, 4608000, 0
buffer_load_dwordx4 v240, s[8:11], s80 offen  lds
s_add_u32 s80, s89, -9216
s_add_u32 m0, s84, 9216
s_cmp_lt_u32 s80, 4608000
s_cselect_b32 s10, 4608000, 0
buffer_load_dwordx4 v240, s[8:11], s80 offen  lds
s_add_u32 s80, s89, 0
s_add_u32 m0, s84, 90112
s_mov_b32 s10, 4608000
buffer_load_dwordx4 v240, s[8:11], s80 offen  lds
s_add_u32 s80, s89, 9216
s_add_u32 m0, s84, 99328
s_mov_b32 s10, 4608000
buffer_load_dwordx4 v240, s[8:11], s80 offen  lds
s_setprio 1
s_mul_i32 s88, s3, 9216
s_add_u32 s88, s88, 8192
s_mul_i32 s38, s53, 36864
s_add_u32 s93, s88, s38
s_add_u32 s93, s93, s58
s_sub_u32 s93, s93, s57
s_mov_b64 s[38:39], 0x3ffff
s_lshl_b64 vcc, s[38:39], 46
s_lshl_b64 s[38:39], s[38:39], 28
v_cndmask_b32 v241, v4, v250, s[38:39]
v_cndmask_b32 v241, v241, v251, vcc
s_add_u32 s37, s82, 1
s_and_b32 s37, s37, 3
s_mul_i32 s38, s37, 18432
s_add_u32 s85, s38, s57
s_mul_i32 s38, s37, 55296
s_add_u32 s90, s38, s58
s_add_u32 s37, s82, 2
s_and_b32 s37, s37, 3
s_mul_i32 s38, s37, 18432
s_add_u32 s86, s38, s57
s_mul_i32 s38, s37, 55296
s_add_u32 s91, s38, s58
s_add_u32 s37, s82, 3
s_and_b32 s37, s37, 3
s_mul_i32 s38, s37, 18432
s_add_u32 s87, s38, s57
s_mul_i32 s38, s37, 55296
s_add_u32 s92, s38, s58
s_cmp_ge_u32 s32, 3
s_cselect_b32 s37, 3, 0
s_sub_u32 s37, s32, s37
s_cmp_ge_u32 s33, 30
s_cselect_b32 s37, s37, 0
s_lshl1_add_u32 s52, s37, s82
s_mov_b64 s[24:25], s[22:23]
s_mov_b32 s26, 256
s_mov_b32 s27, 0x20000
s_add_u32 s20, s20, s54
s_addc_u32 s21, s21, 0
s_mov_b32 s22, 4608000
s_mov_b32 s23, 0x20000
s_mov_b32 s14, 5308416
s_mov_b32 s15, 0x20000
s_and_b32 s37, s3, 1
s_mul_i32 s56, s55, 192
s_add_u32 s56, s56, s37
s_mul_i32 s56, s56, 288
s_and_b32 s37, s3, 1
s_lshl1_add_u32 s40, s36, s37
s_mov_b32 s45, 3182996027
s_cmp_ge_u32 s40, 9
s_cselect_b32 s37, 9, 0
s_cselect_b32 s41, 128, 0
s_cselect_b32 s45, 3174607419, s45
s_sub_u32 s40, s40, s37
s_and_b32 s37, s35, 28
s_add_u32 s37, s37, s35
s_lshl_b32 s37, s37, 8
s_add_u32 s46, s37, s41
s_mul_i32 s37, s53, 110592
s_add_u32 s46, s46, s37
s_cmp_lt_u32 s35, 16
s_cselect_b32 s37, 64, 32
s_lshl4_add_u32 s47, s37, s46
s_add_u32 s48, s46, 442368
s_add_u32 s49, s47, 442368
s_mul_i32 s30, s59, 20736
s_mov_b64 s[28:29], s[12:13]
s_mov_b32 s31, 0x20000
v_bfe_u32 v232, v0, 2, 2
v_and_b32 v233, 2, v0
v_lshl_add_u32 v232, v233, 3, v232
s_lshl_b32 s37, s53, 4
s_sub_u32 s37, s37, 1
v_lshl_add_u32 v232, v232, 2, s37
v_cvt_f32_i32 v232, v232
v_mul_f32 v232, 1006632960, v232
v_lshrrev_b32 v233, 4, v0
v_lshl_add_u32 v233, v233, 2, 2
v_cvt_f32_u32 v233, v233
v_and_b32 v234, 1, v0
v_cvt_f32_u32 v234, v234
v_mul_f32 v234, 1048576000, v234
v_fma_f32 v233, v232, v233, v234
v_fmamk_f32 v192, v232, 0, v233
v_fmamk_f32 v193, v232, 1065353216, v233
v_fmamk_f32 v194, v232, 1073741824, v233
v_fmamk_f32 v195, v232, 1077936128, v233
v_fmamk_f32 v196, v232, 1098907648, v233
v_fmamk_f32 v197, v232, 1099431936, v233
v_fmamk_f32 v198, v232, 1099956224, v233
v_fmamk_f32 v199, v232, 1100480512, v233
s_setprio 0
v_cos_f32 v192, v192
v_cos_f32 v193, v193
v_cos_f32 v194, v194
v_cos_f32 v195, v195
v_cos_f32 v196, v196
v_cos_f32 v197, v197
v_cos_f32 v198, v198
v_cos_f32 v199, v199
v_mul_f32 v192, s45, v192
v_mul_f32 v193, s45, v193
v_mul_f32 v194, s45, v194
v_mul_f32 v195, s45, v195
v_mul_f32 v196, s45, v196
v_mul_f32 v197, s45, v197
v_mul_f32 v198, s45, v198
v_mul_f32 v199, s45, v199
v_cvt_pk_bf16_f32 v224, v192, v193
v_cvt_pk_bf16_f32 v225, v194, v195
v_cvt_pk_bf16_f32 v226, v196, v197
v_cvt_pk_bf16_f32 v227, v198, v199
v_lshlrev_b32 v234, 16, v224
v_and_b32 v235, 0xffff0000, v224
v_sub_f32 v234, v192, v234
v_sub_f32 v235, v193, v235
v_cvt_pk_bf16_f32 v228, v234, v235
v_lshlrev_b32 v234, 16, v225
v_and_b32 v235, 0xffff0000, v225
v_sub_f32 v234, v194, v234
v_sub_f32 v235, v195, v235
v_cvt_pk_bf16_f32 v229, v234, v235
v_lshlrev_b32 v234, 16, v226
v_and_b32 v235, 0xffff0000, v226
v_sub_f32 v234, v196, v234
v_sub_f32 v235, v197, v235
v_cvt_pk_bf16_f32 v230, v234, v235
v_lshlrev_b32 v234, 16, v227
v_and_b32 v235, 0xffff0000, v227
v_sub_f32 v234, v198, v234
v_sub_f32 v235, v199, v235
v_cvt_pk_bf16_f32 v231, v234, v235
v_lshrrev_b32 v232, 2, v0
v_lshlrev_b32 v238, 6, v232
v_lshrrev_b32 v232, 4, v0
v_xor_b32 v233, s3, v232
v_and_b32 v233, 1, v233
v_lshl_add_u32 v238, v233, 5, v238
v_and_b32 v233, 3, v0
v_lshl_add_u32 v238, v233, 3, v238
v_add_u32 v238, 73728, v238
v_mul_u32_u24 v244, 27648, v232
v_and_b32 v233, 7, v0
v_lshl_add_u32 v244, v233, 4, v244
v_bfe_u32 v233, v0, 3, 1
v_lshl_add_u32 v233, s40, 1, v233
v_mul_u32_u24 v234, 43, v233
v_lshrrev_b32 v234, 7, v234
v_mul_u32_u24 v234, 857088, v234
v_mul_u32_u24 v233, 9216, v233
v_add3_u32 v244, v244, v233, v234
s_waitcnt vmcnt(5)
s_barrier
ds_read_b64_tr_b16 v[160:161], v238 offset:0
ds_read_b64_tr_b16 v[162:163], v238 offset:1024
ds_read_b64_tr_b16 v[164:165], v238 offset:2048
ds_read_b64_tr_b16 v[166:167], v238 offset:3072
ds_read_b64_tr_b16 v[168:169], v238 offset:4096
ds_read_b64_tr_b16 v[170:171], v238 offset:5120
ds_read_b64_tr_b16 v[172:173], v238 offset:6144
ds_read_b64_tr_b16 v[174:175], v238 offset:7168
ds_read_b64_tr_b16 v[176:177], v238 offset:8192
ds_read_b64_tr_b16 v[178:179], v238 offset:9216
ds_read_b64_tr_b16 v[180:181], v238 offset:10240
ds_read_b64_tr_b16 v[182:183], v238 offset:11264
ds_read_b64_tr_b16 v[184:185], v238 offset:12288
ds_read_b64_tr_b16 v[186:187], v238 offset:13312
ds_read_b64_tr_b16 v[188:189], v238 offset:14336
ds_read_b64_tr_b16 v[190:191], v238 offset:15360
s_add_u32 s80, s93, -18432
s_add_u32 m0, s88, 0
s_cmp_lt_u32 s80, 4608000
s_cselect_b32 s10, 4608000, 0
buffer_load_dwordx4 v241, s[8:11], s80 offen  lds
s_waitcnt lgkmcnt(14)
v_mfma_f32_16x16x32_bf16 v[192:195], v[224:227], v[160:163], 0
s_waitcnt lgkmcnt(12)
v_mfma_f32_16x16x32_bf16 v[196:199], v[224:227], v[164:167], 0
s_waitcnt lgkmcnt(10)
v_mfma_f32_16x16x32_bf16 v[200:203], v[224:227], v[168:171], 0
s_waitcnt lgkmcnt(8)
v_mfma_f32_16x16x32_bf16 v[204:207], v[224:227], v[172:175], 0
s_waitcnt lgkmcnt(6)
v_mfma_f32_16x16x32_bf16 v[208:211], v[224:227], v[176:179], 0
s_waitcnt lgkmcnt(4)
v_mfma_f32_16x16x32_bf16 v[212:215], v[224:227], v[180:183], 0
s_waitcnt vmcnt(5) lgkmcnt(2)
v_mfma_f32_16x16x32_bf16 v[216:219], v[224:227], v[184:187], 0
s_waitcnt lgkmcnt(0)
v_mfma_f32_16x16x32_bf16 v[220:223], v[224:227], v[188:191], 0
s_add_u32 s80, s93, 0
s_add_u32 m0, s88, 90112
s_mov_b32 s10, 4608000
buffer_load_dwordx4 v241, s[8:11], s80 offen  lds
v_mfma_f32_16x16x32_bf16 v[192:195], v[228:231], v[160:163], v[192:195]
v_mfma_f32_16x16x32_bf16 v[196:199], v[228:231], v[164:167], v[196:199]
v_mfma_f32_16x16x32_bf16 v[200:203], v[228:231], v[168:171], v[200:203]
v_mfma_f32_16x16x32_bf16 v[204:207], v[228:231], v[172:175], v[204:207]
v_mfma_f32_16x16x32_bf16 v[208:211], v[228:231], v[176:179], v[208:211]
v_mfma_f32_16x16x32_bf16 v[212:215], v[228:231], v[180:183], v[212:215]
v_mfma_f32_16x16x32_bf16 v[216:219], v[228:231], v[184:187], v[216:219]
v_mfma_f32_16x16x32_bf16 v[220:223], v[228:231], v[188:191], v[220:223]
s_add_u32 s80, s90, -18432
s_add_u32 m0, s85, 0
s_cmp_lt_u32 s80, 4608000
s_cselect_b32 s10, 4608000, 0
buffer_load_dwordx4 v240, s[8:11], s80 offen  lds
v_cvt_pk_bf16_f32 v132, v192, v196
v_cvt_pk_bf16_f32 v133, v200, v204
v_cvt_pk_bf16_f32 v134, v208, v212
v_cvt_pk_bf16_f32 v135, v216, v220
v_cvt_pk_bf16_f32 v252, v193, v197
v_cvt_pk_bf16_f32 v253, v201, v205
v_cvt_pk_bf16_f32 v254, v209, v213
v_cvt_pk_bf16_f32 v255, v217, v221
v_cvt_pk_bf16_f32 v128, v194, v198
v_cvt_pk_bf16_f32 v129, v202, v206
v_cvt_pk_bf16_f32 v130, v210, v214
v_cvt_pk_bf16_f32 v131, v218, v222
v_cvt_pk_bf16_f32 v248, v195, v199
v_cvt_pk_bf16_f32 v249, v203, v207
v_cvt_pk_bf16_f32 v250, v211, v215
v_cvt_pk_bf16_f32 v251, v219, v223
s_setprio 3
s_add_u32 s80, s90, -9216
s_add_u32 m0, s85, 9216
s_cmp_lt_u32 s80, 4608000
s_cselect_b32 s10, 4608000, 0
buffer_load_dwordx4 v240, s[8:11], s80 offen  lds
v_bfe_u32 v233, v0, 4, 1
v_lshrrev_b32 v234, 5, v0
v_lshl_add_u32 v232, v233, 1, v234
v_bfe_u32 v234, v0, 2, 2
v_lshl_add_u32 v234, v232, 2, v234
v_lshrrev_b32 v235, 3, v234
v_xor_b32 v235, v235, v234
s_xor_b32 s37, s3, 1
v_xor_b32 v235, s37, v235
v_and_b32 v235, 1, v235
v_lshl_add_u32 v234, v234, 1, v235
s_add_u32 s80, s91, -18432
s_add_u32 m0, s86, 0
s_cmp_lt_u32 s80, 4608000
s_cselect_b32 s10, 4608000, 0
buffer_load_dwordx4 v240, s[8:11], s80 offen  lds
v_mul_u32_u24 v7, 288, v234
v_and_b32 v234, 3, v0
v_lshl_add_u32 v7, v234, 3, v7
s_mul_i32 s37, s53, 18432
v_add_u32 v7, s37, v7
v_add_u32 v1, 90112, v7
v_bfe_u32 v233, v0, 4, 1
v_lshrrev_b32 v234, 5, v0
v_lshl_add_u32 v232, v233, 1, v234
v_lshl_add_u32 v233, v232, 4, -1
v_cvt_f32_i32 v233, v233
s_add_u32 s80, s91, -9216
s_add_u32 m0, s86, 9216
s_cmp_lt_u32 s80, 4608000
s_cselect_b32 s10, 4608000, 0
buffer_load_dwordx4 v240, s[8:11], s80 offen  lds
v_bfe_u32 v236, v0, 2, 2
v_and_b32 v234, 1, v0
v_lshl_add_u32 v236, v234, 3, v236
v_and_b32 v234, 2, v0
v_lshl_add_u32 v236, v234, 1, v236
v_add_u32 v234, 0, v236
v_lshl_add_u32 v234, v234, 2, -1
v_cvt_f32_i32 v234, v234
v_mul_f32 v234, 989855744, v234
v_mul_f32 v235, v234, v233
v_fmamk_f32 v32, v234, 0, v235
s_setprio 2
s_add_u32 s80, s92, -18432
s_add_u32 m0, s87, 0
s_cmp_lt_u32 s80, 4608000
s_cselect_b32 s10, 4608000, 0
buffer_load_dwordx4 v240, s[8:11], s80 offen  lds
v_fmamk_f32 v33, v234, 1082130432, v235
v_fmamk_f32 v34, v234, 1090519040, v235
v_fmamk_f32 v35, v234, 1094713344, v235
v_fmamk_f32 v36, v234, 1115684864, v235
v_fmamk_f32 v37, v234, 1116209152, v235
v_fmamk_f32 v38, v234, 1116733440, v235
v_fmamk_f32 v39, v234, 1117257728, v235
v_sin_f32 v40, v32
v_cos_f32 v32, v32
v_sin_f32 v41, v33
v_cos_f32 v33, v33
s_add_u32 s80, s92, -9216
s_add_u32 m0, s87, 9216
s_cmp_lt_u32 s80, 4608000
s_cselect_b32 s10, 4608000, 0
buffer_load_dwordx4 v240, s[8:11], s80 offen  lds
v_sin_f32 v42, v34
v_cos_f32 v34, v34
v_sin_f32 v43, v35
v_cos_f32 v35, v35
v_sin_f32 v44, v36
v_cos_f32 v36, v36
v_sin_f32 v45, v37
v_cos_f32 v37, v37
v_sin_f32 v46, v38
v_cos_f32 v38, v38
v_sin_f32 v47, v39
s_add_u32 s80, s90, 0
s_add_u32 m0, s85, 90112
s_mov_b32 s10, 4608000
buffer_load_dwordx4 v240, s[8:11], s80 offen  lds
v_cos_f32 v39, v39
v_cvt_pk_bf16_f32 v16, v40, v41
v_cvt_pk_bf16_f32 v8, v32, v33
v_cvt_pk_bf16_f32 v17, v42, v43
v_cvt_pk_bf16_f32 v9, v34, v35
v_cvt_pk_bf16_f32 v18, v44, v45
v_cvt_pk_bf16_f32 v10, v36, v37
v_cvt_pk_bf16_f32 v19, v46, v47
v_cvt_pk_bf16_f32 v11, v38, v39
v_xor_b32 v24, 0x80008000, v8
v_xor_b32 v25, 0x80008000, v9
s_setprio 1
s_add_u32 s80, s90, 9216
s_add_u32 m0, s85, 99328
s_mov_b32 s10, 4608000
buffer_load_dwordx4 v240, s[8:11], s80 offen  lds
v_xor_b32 v26, 0x80008000, v10
v_xor_b32 v27, 0x80008000, v11
v_add_u32 v234, 16, v236
v_lshl_add_u32 v234, v234, 2, -1
v_cvt_f32_i32 v234, v234
v_mul_f32 v234, 989855744, v234
v_mul_f32 v235, v234, v233
v_fmamk_f32 v32, v234, 0, v235
v_fmamk_f32 v33, v234, 1082130432, v235
v_fmamk_f32 v34, v234, 1090519040, v235
v_fmamk_f32 v35, v234, 1094713344, v235
s_add_u32 s80, s91, 0
s_add_u32 m0, s86, 90112
s_mov_b32 s10, 4608000
buffer_load_dwordx4 v240, s[8:11], s80 offen  lds
v_fmamk_f32 v36, v234, 1115684864, v235
v_fmamk_f32 v37, v234, 1116209152, v235
v_fmamk_f32 v38, v234, 1116733440, v235
v_fmamk_f32 v39, v234, 1117257728, v235
v_sin_f32 v40, v32
v_cos_f32 v32, v32
v_sin_f32 v41, v33
v_cos_f32 v33, v33
v_sin_f32 v42, v34
v_cos_f32 v34, v34
v_sin_f32 v43, v35
s_add_u32 s80, s91, 9216
s_add_u32 m0, s86, 99328
s_mov_b32 s10, 4608000
buffer_load_dwordx4 v240, s[8:11], s80 offen  lds
v_cos_f32 v35, v35
v_sin_f32 v44, v36
v_cos_f32 v36, v36
v_sin_f32 v45, v37
v_cos_f32 v37, v37
v_sin_f32 v46, v38
v_cos_f32 v38, v38
v_sin_f32 v47, v39
v_cos_f32 v39, v39
v_cvt_pk_bf16_f32 v20, v40, v41
v_cvt_pk_bf16_f32 v12, v32, v33
s_setprio 0
s_add_u32 s80, s92, 0
s_add_u32 m0, s87, 90112
s_mov_b32 s10, 4608000
buffer_load_dwordx4 v240, s[8:11], s80 offen  lds
v_cvt_pk_bf16_f32 v21, v42, v43
v_cvt_pk_bf16_f32 v13, v34, v35
v_cvt_pk_bf16_f32 v22, v44, v45
v_cvt_pk_bf16_f32 v14, v36, v37
v_cvt_pk_bf16_f32 v23, v46, v47
v_cvt_pk_bf16_f32 v15, v38, v39
v_xor_b32 v28, 0x80008000, v12
v_xor_b32 v29, 0x80008000, v13
v_xor_b32 v30, 0x80008000, v14
v_xor_b32 v31, 0x80008000, v15
s_mul_i32 s62, s3, 4128
s_add_u32 s80, s92, 9216
s_add_u32 m0, s87, 99328
s_mov_b32 s10, 4608000
buffer_load_dwordx4 v240, s[8:11], s80 offen  lds
s_waitcnt vmcnt(6)
s_barrier
s_and_b32 s37, s3, 1
s_lshl1_add_u32 s37, s82, s37
s_mul_i32 s37, s37, 1536
s_mul_i32 s38, s55, 55296
s_add_u32 s37, s37, s38
s_add_u32 s37, s37, 18432
v_min_u32 v144, 11, v0
v_lshl_add_u32 v144, v144, 7, s37
v_max_i32 v144, 0, v144
s_mov_b32 s10, 4608000
buffer_load_dword v144, v144, s[8:11], 0 offen
ds_read_b64_tr_b16 v[64:65], v7 offset:0
ds_read_b64_tr_b16 v[66:67], v7 offset:9216
ds_read_b64_tr_b16 v[68:69], v7 offset:32
ds_read_b64_tr_b16 v[70:71], v7 offset:9248
ds_read_b64_tr_b16 v[72:73], v7 offset:64
ds_read_b64_tr_b16 v[74:75], v7 offset:9280
ds_read_b64_tr_b16 v[76:77], v7 offset:96
ds_read_b64_tr_b16 v[78:79], v7 offset:9312
ds_read_b64_tr_b16 v[80:81], v7 offset:128
ds_read_b64_tr_b16 v[82:83], v7 offset:9344
ds_read_b64_tr_b16 v[84:85], v7 offset:160
ds_read_b64_tr_b16 v[86:87], v7 offset:9376
ds_read_b64_tr_b16 v[88:89], v7 offset:192
ds_read_b64_tr_b16 v[90:91], v7 offset:9408
ds_read_b64_tr_b16 v[92:93], v7 offset:224
ds_read_b64_tr_b16 v[94:95], v7 offset:9440
ds_read_b64_tr_b16 v[48:49], v7 offset:256
ds_read_b64_tr_b16 v[50:51], v7 offset:9472
ds_read_b64_tr_b16 v[160:161], v7 offset:18432
ds_read_b64_tr_b16 v[162:163], v7 offset:27648
ds_read_b64_tr_b16 v[164:165], v7 offset:18464
ds_read_b64_tr_b16 v[166:167], v7 offset:27680
ds_read_b64_tr_b16 v[168:169], v7 offset:18496
ds_read_b64_tr_b16 v[170:171], v7 offset:27712
ds_read_b64_tr_b16 v[172:173], v7 offset:18528
ds_read_b64_tr_b16 v[174:175], v7 offset:27744
ds_read_b64_tr_b16 v[176:177], v7 offset:18560
ds_read_b64_tr_b16 v[178:179], v7 offset:27776
ds_read_b64_tr_b16 v[180:181], v7 offset:18592
ds_read_b64_tr_b16 v[182:183], v7 offset:27808
ds_read_b64_tr_b16 v[184:185], v7 offset:18624
ds_read_b64_tr_b16 v[186:187], v7 offset:27840
ds_read_b64_tr_b16 v[188:189], v7 offset:18656
ds_read_b64_tr_b16 v[190:191], v7 offset:27872
ds_read_b64_tr_b16 v[60:61], v7 offset:18688
ds_read_b64_tr_b16 v[62:63], v7 offset:27904
s_waitcnt vmcnt(1)
s_waitcnt lgkmcnt(0)
s_barrier
ds_read_b64_tr_b16 v[96:97], v1 offset:0
ds_read_b64_tr_b16 v[98:99], v1 offset:9216
ds_read_b64_tr_b16 v[100:101], v1 offset:32
ds_read_b64_tr_b16 v[102:103], v1 offset:9248
ds_read_b64_tr_b16 v[104:105], v1 offset:64
ds_read_b64_tr_b16 v[106:107], v1 offset:9280
ds_read_b64_tr_b16 v[108:109], v1 offset:96
ds_read_b64_tr_b16 v[110:111], v1 offset:9312
ds_read_b64_tr_b16 v[112:113], v1 offset:128
ds_read_b64_tr_b16 v[114:115], v1 offset:9344
ds_read_b64_tr_b16 v[116:117], v1 offset:160
ds_read_b64_tr_b16 v[118:119], v1 offset:9376
ds_read_b64_tr_b16 v[120:121], v1 offset:192
ds_read_b64_tr_b16 v[122:123], v1 offset:9408
ds_read_b64_tr_b16 v[124:125], v1 offset:224
ds_read_b64_tr_b16 v[126:127], v1 offset:9440
ds_read_b64_tr_b16 v[52:53], v1 offset:256
ds_read_b64_tr_b16 v[54:55], v1 offset:9472
s_mov_b32 m0, s62
v_mfma_f32_16x16x32_bf16 v[36:39], v[8:11], v[68:71], 0
v_lshrrev_b32 v2, 4, v0
s_and_b32 s42, s3, 3
s_waitcnt lgkmcnt(14)
v_mfma_f32_16x16x32_bf16 v[36:39], v[16:19], v[100:103], v[36:39]
s_lshl_b32 s42, s42, 6
s_lshr_b32 s43, s3, 2
v_mfma_f32_16x16x32_bf16 v[32:35], v[8:11], v[64:67], 0
s_mul_i32 s43, s43, 2080
s_add_u32 s61, s42, s43
v_mfma_f32_16x16x32_bf16 v[32:35], v[16:19], v[96:99], v[32:35]
v_and_b32 v242, 7, v0
v_mul_u32_u24 v242, 4128, v242
v_mfma_f32_16x16x32_bf16 v[44:47], v[16:19], v[68:71], 0
v_bfe_u32 v243, v0, 3, 1
v_lshl_add_u32 v242, v243, 10, v242
v_mfma_f32_16x16x32_bf16 v[44:47], v[24:27], v[100:103], v[44:47]
v_add_u32 v242, s61, v242
v_lshl_add_u32 v3, v2, 4, v242
v_mfma_f32_16x16x32_bf16 v[40:43], v[16:19], v[64:67], 0
v_lshrrev_b32 v243, 1, v0
v_xor_b32 v243, v243, v0
v_cvt_pk_bf16_f32 v32, v32, v36
v_cvt_pk_bf16_f32 v33, v33, v37
s_cmp_lg_u32 s3, 0
s_cbranch_scc1 L_w0c
s_cmp_eq_u32 s3, 0
s_cselect_b32 s26, 256, 0
buffer_load_dword v7, off, s[24:27], 0 sc1
L_w0c:
v_mfma_f32_16x16x32_bf16 v[40:43], v[24:27], v[96:99], v[40:43]
v_and_b32 v243, 8, v243
v_lshl_add_u32 v6, v243, 1, v242
v_cvt_pk_bf16_f32 v34, v34, v38
v_cvt_pk_bf16_f32 v35, v35, v39
v_mfma_f32_16x16x32_bf16 v[36:39], v[12:15], v[68:71], 0
v_lshrrev_b32 v243, 5, v0
v_lshl_add_u32 v6, v243, 2, v6
s_waitcnt lgkmcnt(0)
s_barrier
ds_write_addtid_b32 v32 offset:0
ds_write_addtid_b32 v33 offset:2080
s_setprio 3
v_mfma_f32_16x16x32_bf16 v[36:39], v[20:23], v[100:103], v[36:39]
v_and_b32 v242, 7, v0
v_mul_u32_u24 v242, 4128, v242
ds_write_addtid_b32 v34 offset:256
ds_write_addtid_b32 v35 offset:2336
s_add_u32 s80, s89, 18432
s_add_u32 m0, s84, 90112
s_cmp_lt_u32 s80, 4608000
s_cselect_b32 s10, 4608000, 0
buffer_load_dwordx4 v240, s[8:11], s80 offen  lds
s_mov_b32 m0, s62
v_mfma_f32_16x16x32_bf16 v[32:35], v[12:15], v[64:67], 0
v_lshrrev_b32 v243, 2, v0
v_xor_b32 v243, v243, v0
v_cvt_pk_bf16_f32 v40, v40, v44
v_cvt_pk_bf16_f32 v41, v41, v45
v_mfma_f32_16x16x32_bf16 v[32:35], v[20:23], v[96:99], v[32:35]
v_and_b32 v243, 8, v243
v_lshl_add_u32 v242, v243, 7, v242
v_cvt_pk_bf16_f32 v42, v42, v46
v_cvt_pk_bf16_f32 v43, v43, v47
v_mfma_f32_16x16x32_bf16 v[44:47], v[20:23], v[68:71], 0
s_lshr_b32 s42, s3, 1
v_xor_b32 v243, s42, v2
ds_write_addtid_b32 v40 offset:1024
ds_write_addtid_b32 v41 offset:3104
s_setprio 2
v_mfma_f32_16x16x32_bf16 v[44:47], v[28:31], v[100:103], v[44:47]
v_and_b32 v243, 1, v243
v_lshl_add_u32 v242, v243, 4, v242
ds_write_addtid_b32 v42 offset:1280
ds_write_addtid_b32 v43 offset:3360
s_add_u32 s80, s89, 27648
s_add_u32 m0, s84, 99328
s_cmp_lt_u32 s80, 4608000
s_cselect_b32 s10, 4608000, 0
buffer_load_dwordx4 v240, s[8:11], s80 offen  lds
s_mov_b32 m0, s62
v_mfma_f32_16x16x32_bf16 v[40:43], v[20:23], v[64:67], 0
s_add_u32 s42, s61, 99072
v_add_u32 v5, s42, v242
v_cvt_pk_bf16_f32 v32, v32, v36
v_cvt_pk_bf16_f32 v33, v33, v37
v_mfma_f32_16x16x32_bf16 v[40:43], v[28:31], v[96:99], v[40:43]
s_lshr_b32 s42, s3, 1
s_mul_i32 s63, s42, 4160
v_cvt_pk_bf16_f32 v34, v34, v38
v_cvt_pk_bf16_f32 v35, v35, v39
v_mfma_f32_16x16x32_bf16 v[36:39], v[8:11], v[76:79], 0
s_and_b32 s42, s3, 1
s_lshl_b32 s42, s42, 5
ds_write_addtid_b32 v32 offset:512
ds_write_addtid_b32 v33 offset:2592
s_setprio 1
v_mfma_f32_16x16x32_bf16 v[36:39], v[16:19], v[108:111], v[36:39]
s_add_u32 s63, s63, s42
ds_write_addtid_b32 v34 offset:768
ds_write_addtid_b32 v35 offset:2848
s_add_u32 s80, s93, 18432
s_add_u32 m0, s88, 90112
s_cmp_lt_u32 s80, 4608000
s_cselect_b32 s10, 4608000, 0
buffer_load_dwordx4 v241, s[8:11], s80 offen  lds
s_mov_b32 m0, s62
v_mfma_f32_16x16x32_bf16 v[32:35], v[8:11], v[72:75], 0
v_cvt_pk_bf16_f32 v40, v40, v44
v_cvt_pk_bf16_f32 v41, v41, v45
v_mfma_f32_16x16x32_bf16 v[32:35], v[16:19], v[104:107], v[32:35]
v_cvt_pk_bf16_f32 v42, v42, v46
v_cvt_pk_bf16_f32 v43, v43, v47
v_mfma_f32_16x16x32_bf16 v[44:47], v[16:19], v[76:79], 0
ds_write_addtid_b32 v40 offset:1536
ds_write_addtid_b32 v41 offset:3616
s_setprio 0
v_mfma_f32_16x16x32_bf16 v[44:47], v[24:27], v[108:111], v[44:47]
ds_write_addtid_b32 v42 offset:1792
ds_write_addtid_b32 v43 offset:3872
s_add_u32 s80, s90, 18432
s_add_u32 m0, s85, 90112
s_cmp_lt_u32 s80, 4608000
s_cselect_b32 s10, 4608000, 0
buffer_load_dwordx4 v240, s[8:11], s80 offen  lds
s_mov_b32 m0, s62
v_mfma_f32_16x16x32_bf16 v[40:43], v[16:19], v[72:75], 0
v_cvt_pk_bf16_f32 v32, v32, v36
v_cvt_pk_bf16_f32 v33, v33, v37
v_mfma_f32_16x16x32_bf16 v[40:43], v[24:27], v[104:107], v[40:43]
v_cvt_pk_bf16_f32 v34, v34, v38
v_cvt_pk_bf16_f32 v35, v35, v39
v_mfma_f32_16x16x32_bf16 v[36:39], v[12:15], v[76:79], 0
s_and_b32 s38, s3, 4
s_waitcnt lgkmcnt(0)
s_barrier
ds_write_addtid_b32 v32 offset:33024
ds_write_addtid_b32 v33 offset:35104
s_setprio 3
v_mfma_f32_16x16x32_bf16 v[36:39], v[20:23], v[108:111], v[36:39]
s_add_u32 s38, s38, s3
ds_write_addtid_b32 v34 offset:33280
ds_write_addtid_b32 v35 offset:35360
s_add_u32 s80, s90, 27648
s_add_u32 m0, s85, 99328
s_cmp_lt_u32 s80, 4608000
s_cselect_b32 s10, 4608000, 0
buffer_load_dwordx4 v240, s[8:11], s80 offen  lds
s_mov_b32 m0, s62
v_mfma_f32_16x16x32_bf16 v[32:35], v[12:15], v[72:75], 0
s_lshl_b32 s60, s52, 5
v_cvt_pk_bf16_f32 v40, v40, v44
v_cvt_pk_bf16_f32 v41, v41, v45
ds_read_b128 v[192:195], v3 offset:0
v_mfma_f32_16x16x32_bf16 v[32:35], v[20:23], v[104:107], v[32:35]
s_add_u32 s60, s60, s38
v_cvt_pk_bf16_f32 v42, v42, v46
v_cvt_pk_bf16_f32 v43, v43, v47
ds_read_b128 v[196:199], v3 offset:256
v_mfma_f32_16x16x32_bf16 v[44:47], v[20:23], v[76:79], 0
s_mul_i32 s60, s60, 27648
ds_write_addtid_b32 v40 offset:34048
ds_write_addtid_b32 v41 offset:36128
s_setprio 2
v_mfma_f32_16x16x32_bf16 v[44:47], v[28:31], v[108:111], v[44:47]
s_add_u32 s40, s60, 0
ds_write_addtid_b32 v42 offset:34304
ds_write_addtid_b32 v43 offset:36384
s_add_u32 s80, s91, 18432
s_add_u32 m0, s86, 90112
s_cmp_lt_u32 s80, 4608000
s_cselect_b32 s10, 4608000, 0
buffer_load_dwordx4 v240, s[8:11], s80 offen  lds
s_mov_b32 m0, s62
v_mfma_f32_16x16x32_bf16 v[40:43], v[20:23], v[72:75], 0
s_add_u32 s41, s40, 4096
v_cvt_pk_bf16_f32 v32, v32, v36
v_cvt_pk_bf16_f32 v33, v33, v37
ds_read_b128 v[200:203], v3 offset:512
v_mfma_f32_16x16x32_bf16 v[40:43], v[28:31], v[104:107], v[40:43]
s_add_u32 s42, s40, 8192
v_cvt_pk_bf16_f32 v34, v34, v38
v_cvt_pk_bf16_f32 v35, v35, v39
v_mfma_f32_16x16x32_bf16 v[36:39], v[8:11], v[84:87], 0
ds_write_addtid_b32 v32 offset:33536
ds_write_addtid_b32 v33 offset:35616
s_setprio 1
v_mfma_f32_16x16x32_bf16 v[36:39], v[16:19], v[116:119], v[36:39]
ds_write_addtid_b32 v34 offset:33792
ds_write_addtid_b32 v35 offset:35872
s_add_u32 s80, s91, 27648
s_add_u32 m0, s86, 99328
s_cmp_lt_u32 s80, 4608000
s_cselect_b32 s10, 4608000, 0
buffer_load_dwordx4 v240, s[8:11], s80 offen  lds
s_mov_b32 m0, s62
v_mfma_f32_16x16x32_bf16 v[32:35], v[8:11], v[80:83], 0
v_cvt_pk_bf16_f32 v40, v40, v44
v_cvt_pk_bf16_f32 v41, v41, v45
ds_read_b128 v[204:207], v3 offset:768
v_mfma_f32_16x16x32_bf16 v[32:35], v[16:19], v[112:115], v[32:35]
v_cvt_pk_bf16_f32 v42, v42, v46
v_cvt_pk_bf16_f32 v43, v43, v47
s_add_u32 s80, s58, 202752
s_add_u32 m0, s57, 71680
s_cmp_lt_u32 s80, 4608000
s_cselect_b32 s10, 4608000, 0
buffer_load_dwordx4 v240, s[8:11], s80 offen  lds
s_mov_b32 m0, s62
v_mfma_f32_16x16x32_bf16 v[44:47], v[16:19], v[84:87], 0
ds_write_addtid_b32 v40 offset:34560
ds_write_addtid_b32 v41 offset:36640
s_setprio 0
v_mfma_f32_16x16x32_bf16 v[44:47], v[24:27], v[116:119], v[44:47]
ds_write_addtid_b32 v42 offset:34816
ds_write_addtid_b32 v43 offset:36896
s_add_u32 s80, s92, 18432
s_add_u32 m0, s87, 90112
s_cmp_lt_u32 s80, 4608000
s_cselect_b32 s10, 4608000, 0
buffer_load_dwordx4 v240, s[8:11], s80 offen  lds
s_mov_b32 m0, s62
v_mfma_f32_16x16x32_bf16 v[40:43], v[16:19], v[80:83], 0
v_cvt_pk_bf16_f32 v32, v32, v36
v_cvt_pk_bf16_f32 v33, v33, v37
v_mfma_f32_16x16x32_bf16 v[40:43], v[24:27], v[112:115], v[40:43]
v_cvt_pk_bf16_f32 v34, v34, v38
v_cvt_pk_bf16_f32 v35, v35, v39
s_add_u32 s80, s58, 211968
s_add_u32 m0, s57, 80896
s_cmp_lt_u32 s80, 4608000
s_cselect_b32 s10, 4608000, 0
buffer_load_dwordx4 v240, s[8:11], s80 offen  lds
s_mov_b32 m0, s62
v_mfma_f32_16x16x32_bf16 v[36:39], v[12:15], v[84:87], 0
s_waitcnt lgkmcnt(0)
s_barrier
ds_write_addtid_b32 v32 offset:0
ds_write_addtid_b32 v33 offset:2080
s_setprio 3
v_mfma_f32_16x16x32_bf16 v[36:39], v[20:23], v[116:119], v[36:39]
ds_write_addtid_b32 v34 offset:256
ds_write_addtid_b32 v35 offset:2336
s_add_u32 s80, s92, 27648
s_add_u32 m0, s87, 99328
s_cmp_lt_u32 s80, 4608000
s_cselect_b32 s10, 4608000, 0
buffer_load_dwordx4 v240, s[8:11], s80 offen  lds
s_mov_b32 m0, s62
v_mfma_f32_16x16x32_bf16 v[32:35], v[12:15], v[80:83], 0
v_cvt_pk_bf16_f32 v40, v40, v44
v_cvt_pk_bf16_f32 v41, v41, v45
ds_read_b128 v[208:211], v3 offset:33024
v_mfma_f32_16x16x32_bf16 v[32:35], v[20:23], v[112:115], v[32:35]
v_cvt_pk_bf16_f32 v42, v42, v46
v_cvt_pk_bf16_f32 v43, v43, v47
ds_read_b128 v[212:215], v3 offset:33280
s_cmp_ge_u32 s3, 2
s_cbranch_scc1 L_skip
s_add_u32 s80, s93, 202752
s_add_u32 m0, s88, 71680
s_cmp_lt_u32 s80, 4608000
s_cselect_b32 s10, 4608000, 0
buffer_load_dwordx4 v241, s[8:11], s80 offen  lds
s_mov_b32 m0, s62
L_skip:
v_mfma_f32_16x16x32_bf16 v[44:47], v[20:23], v[84:87], 0
s_nop 0
ds_write_addtid_b32 v40 offset:1024
ds_write_addtid_b32 v41 offset:3104
s_setprio 2
buffer_store_dwordx4 v[128:131], v244, s[28:31], s48 offen sc1
v_mfma_f32_16x16x32_bf16 v[44:47], v[28:31], v[116:119], v[44:47]
ds_write_addtid_b32 v42 offset:1280
ds_write_addtid_b32 v43 offset:3360
v_mfma_f32_16x16x32_bf16 v[40:43], v[20:23], v[80:83], 0
v_cvt_pk_bf16_f32 v32, v32, v36
v_cvt_pk_bf16_f32 v33, v33, v37
ds_read_b128 v[216:219], v3 offset:33536
v_mfma_f32_16x16x32_bf16 v[40:43], v[28:31], v[112:115], v[40:43]
v_cvt_pk_bf16_f32 v34, v34, v38
v_cvt_pk_bf16_f32 v35, v35, v39
v_mfma_f32_16x16x32_bf16 v[36:39], v[8:11], v[92:95], 0
ds_write_addtid_b32 v32 offset:512
ds_write_addtid_b32 v33 offset:2592
s_setprio 1
v_mfma_f32_16x16x32_bf16 v[36:39], v[16:19], v[124:127], v[36:39]
ds_write_addtid_b32 v34 offset:768
ds_write_addtid_b32 v35 offset:2848
v_mfma_f32_16x16x32_bf16 v[32:35], v[8:11], v[88:91], 0
v_cvt_pk_bf16_f32 v40, v40, v44
v_cvt_pk_bf16_f32 v41, v41, v45
ds_read_b128 v[220:223], v3 offset:33792
buffer_store_dwordx4 v[132:135], v244, s[28:31], s46 offen sc1
v_mfma_f32_16x16x32_bf16 v[32:35], v[16:19], v[120:123], v[32:35]
v_cvt_pk_bf16_f32 v42, v42, v46
v_cvt_pk_bf16_f32 v43, v43, v47
v_mfma_f32_16x16x32_bf16 v[44:47], v[16:19], v[92:95], 0
v_add_u32 v2, -73728, v1
ds_write_addtid_b32 v40 offset:1536
ds_write_addtid_b32 v41 offset:3616
s_setprio 0
v_mfma_f32_16x16x32_bf16 v[44:47], v[24:27], v[124:127], v[44:47]
ds_write_addtid_b32 v42 offset:1792
ds_write_addtid_b32 v43 offset:3872
v_mfma_f32_16x16x32_bf16 v[40:43], v[16:19], v[88:91], 0
v_cvt_pk_bf16_f32 v32, v32, v36
v_cvt_pk_bf16_f32 v33, v33, v37
v_mfma_f32_16x16x32_bf16 v[40:43], v[24:27], v[120:123], v[40:43]
v_cvt_pk_bf16_f32 v34, v34, v38
v_cvt_pk_bf16_f32 v35, v35, v39
v_mfma_f32_16x16x32_bf16 v[36:39], v[12:15], v[92:95], 0
s_waitcnt vmcnt(2)
s_waitcnt lgkmcnt(0)
s_barrier
ds_write_addtid_b32 v32 offset:33024
ds_write_addtid_b32 v33 offset:35104
s_setprio 3
v_mfma_f32_16x16x32_bf16 v[36:39], v[20:23], v[124:127], v[36:39]
ds_write_addtid_b32 v34 offset:33280
ds_write_addtid_b32 v35 offset:35360
s_cmp_lt_u32 s3, 6
s_cbranch_scc1 L_nopull0
ds_read_b64_tr_b16 v[160:161], v2 offset:0
ds_read_b64_tr_b16 v[162:163], v2 offset:9216
ds_read_b64_tr_b16 v[164:165], v2 offset:32
ds_read_b64_tr_b16 v[166:167], v2 offset:9248
ds_read_b64_tr_b16 v[168:169], v2 offset:64
ds_read_b64_tr_b16 v[170:171], v2 offset:9280
L_nopull0:
v_mfma_f32_16x16x32_bf16 v[32:35], v[12:15], v[88:91], 0
v_cvt_pk_bf16_f32 v40, v40, v44
v_cvt_pk_bf16_f32 v41, v41, v45
ds_read_b64_tr_b16 v[128:129], v1 offset:0
ds_read_b64_tr_b16 v[130:131], v1 offset:9216
ds_read_b64_tr_b16 v[132:133], v1 offset:32
ds_read_b128 v[224:227], v3 offset:0
buffer_store_dwordx4 v[248:251], v244, s[28:31], s49 offen sc1
v_mfma_f32_16x16x32_bf16 v[32:35], v[20:23], v[120:123], v[32:35]
v_cvt_pk_bf16_f32 v42, v42, v46
v_cvt_pk_bf16_f32 v43, v43, v47
ds_read_b64_tr_b16 v[134:135], v1 offset:9248
ds_read_b64_tr_b16 v[136:137], v1 offset:64
ds_read_b64_tr_b16 v[138:139], v1 offset:9280
ds_read_b128 v[228:231], v3 offset:256
v_mfma_f32_16x16x32_bf16 v[44:47], v[20:23], v[92:95], 0
ds_write_addtid_b32 v40 offset:34048
ds_write_addtid_b32 v41 offset:36128
s_setprio 2
s_cmp_lt_u32 s3, 6
s_cbranch_scc1 L_nopull1
ds_read_b64_tr_b16 v[172:173], v2 offset:96
ds_read_b64_tr_b16 v[174:175], v2 offset:9312
ds_read_b64_tr_b16 v[176:177], v2 offset:128
ds_read_b64_tr_b16 v[178:179], v2 offset:9344
ds_read_b64_tr_b16 v[180:181], v2 offset:160
ds_read_b64_tr_b16 v[182:183], v2 offset:9376
L_nopull1:
v_mfma_f32_16x16x32_bf16 v[44:47], v[28:31], v[124:127], v[44:47]
ds_write_addtid_b32 v42 offset:34304
ds_write_addtid_b32 v43 offset:36384
s_cmp_lt_u32 s3, 6
s_cbranch_scc1 L_nopull2
ds_read_b64_tr_b16 v[184:185], v2 offset:192
ds_read_b64_tr_b16 v[186:187], v2 offset:9408
ds_read_b64_tr_b16 v[188:189], v2 offset:224
ds_read_b64_tr_b16 v[190:191], v2 offset:9440
ds_read_b64_tr_b16 v[60:61], v2 offset:256
ds_read_b64_tr_b16 v[62:63], v2 offset:9472
L_nopull2:
v_mfma_f32_16x16x32_bf16 v[40:43], v[20:23], v[88:91], 0
v_cvt_pk_bf16_f32 v32, v32, v36
v_cvt_pk_bf16_f32 v33, v33, v37
ds_read_b64_tr_b16 v[140:141], v1 offset:96
ds_read_b64_tr_b16 v[142:143], v1 offset:9312
ds_read_b64_tr_b16 v[144:145], v1 offset:128
ds_read_b128 v[232:235], v3 offset:512
v_mfma_f32_16x16x32_bf16 v[40:43], v[28:31], v[120:123], v[40:43]
v_cvt_pk_bf16_f32 v34, v34, v38
v_cvt_pk_bf16_f32 v35, v35, v39
ds_read_b64_tr_b16 v[146:147], v1 offset:9344
ds_read_b64_tr_b16 v[148:149], v1 offset:160
ds_read_b64_tr_b16 v[150:151], v1 offset:9376
s_waitcnt lgkmcnt(8)
v_mfma_f32_16x16x32_bf16 v[84:87], v[16:19], v[132:135], 0
v_xor_b32 v164, 0x80008000, v164
v_xor_b32 v165, 0x80008000, v165
ds_write_addtid_b32 v32 offset:33536
ds_write_addtid_b32 v33 offset:35616
s_setprio 1
v_mfma_f32_16x16x32_bf16 v[80:83], v[16:19], v[128:131], 0
v_xor_b32 v166, 0x80008000, v166
v_xor_b32 v167, 0x80008000, v167
ds_write_addtid_b32 v34 offset:33792
ds_write_addtid_b32 v35 offset:35872
v_mfma_f32_16x16x32_bf16 v[92:95], v[8:11], v[100:103], v[84:87]
v_xor_b32 v160, 0x80008000, v160
v_xor_b32 v161, 0x80008000, v161
v_cvt_pk_bf16_f32 v40, v40, v44
v_cvt_pk_bf16_f32 v41, v41, v45
ds_read_b64_tr_b16 v[152:153], v1 offset:192
ds_read_b64_tr_b16 v[154:155], v1 offset:9408
ds_read_b64_tr_b16 v[156:157], v1 offset:224
ds_read_b128 v[236:239], v3 offset:768
v_mfma_f32_16x16x32_bf16 v[88:91], v[8:11], v[96:99], v[80:83]
v_xor_b32 v162, 0x80008000, v162
v_xor_b32 v163, 0x80008000, v163
v_cvt_pk_bf16_f32 v42, v42, v46
v_cvt_pk_bf16_f32 v43, v43, v47
ds_read_b64_tr_b16 v[158:159], v1 offset:9440
ds_read_b64_tr_b16 v[56:57], v1 offset:256
ds_read_b64_tr_b16 v[58:59], v1 offset:9472
v_mfma_f32_16x16x32_bf16 v[84:87], v[8:11], v[164:167], v[84:87]
ds_write_addtid_b32 v40 offset:34560
ds_write_addtid_b32 v41 offset:36640
s_setprio 0
buffer_store_dwordx4 v[252:255], v244, s[28:31], s47 offen sc1
v_mfma_f32_16x16x32_bf16 v[80:83], v[8:11], v[160:163], v[80:83]
ds_write_addtid_b32 v42 offset:34816
ds_write_addtid_b32 v43 offset:36896
v_mfma_f32_16x16x32_bf16 v[36:39], v[24:27], v[132:135], 0
v_xor_b32 v168, 0x80008000, v168
v_cvt_pk_bf16_f32 v88, v88, v92
v_mfma_f32_16x16x32_bf16 v[32:35], v[24:27], v[128:131], 0
v_xor_b32 v169, 0x80008000, v169
v_cvt_pk_bf16_f32 v89, v89, v93
v_mfma_f32_16x16x32_bf16 v[44:47], v[16:19], v[100:103], v[36:39]
v_cvt_pk_bf16_f32 v90, v90, v94
v_cvt_pk_bf16_f32 v91, v91, v95
s_waitcnt lgkmcnt(0)
s_barrier
s_add_u32 m0, s62, 66048
s_nop 0
ds_write_addtid_b32 v88 offset:0
ds_write_addtid_b32 v89 offset:2080
s_setprio 3
v_mfma_f32_16x16x32_bf16 v[40:43], v[16:19], v[96:99], v[32:35]
v_xor_b32 v170, 0x80008000, v170
v_add_u32 v1, 66048, v3
v_cvt_pk_bf16_f32 v80, v80, v84
ds_write_addtid_b32 v90 offset:256
ds_write_addtid_b32 v91 offset:2336
v_mfma_f32_16x16x32_bf16 v[36:39], v[16:19], v[164:167], v[36:39]
v_xor_b32 v171, 0x80008000, v171
v_cvt_pk_bf16_f32 v81, v81, v85
ds_write_addtid_b32 v80 offset:34048
v_mfma_f32_16x16x32_bf16 v[32:35], v[16:19], v[160:163], v[32:35]
v_cvt_pk_bf16_f32 v82, v82, v86
v_cvt_pk_bf16_f32 v83, v83, v87
ds_write_addtid_b32 v81 offset:36128
ds_write_addtid_b32 v82 offset:34304
v_mfma_f32_16x16x32_bf16 v[84:87], v[20:23], v[132:135], 0
v_xor_b32 v172, 0x80008000, v172
v_cvt_pk_bf16_f32 v40, v40, v44
ds_write_addtid_b32 v83 offset:36384
ds_read_b128 v[240:243], v3 offset:33024
v_mfma_f32_16x16x32_bf16 v[80:83], v[20:23], v[128:131], 0
v_xor_b32 v173, 0x80008000, v173
v_cvt_pk_bf16_f32 v41, v41, v45
ds_write_addtid_b32 v40 offset:1024
v_mfma_f32_16x16x32_bf16 v[92:95], v[12:15], v[100:103], v[84:87]
v_cvt_pk_bf16_f32 v42, v42, v46
v_cvt_pk_bf16_f32 v43, v43, v47
ds_write_addtid_b32 v41 offset:3104
ds_write_addtid_b32 v42 offset:1280
s_setprio 2
v_mfma_f32_16x16x32_bf16 v[88:91], v[12:15], v[96:99], v[80:83]
v_xor_b32 v174, 0x80008000, v174
v_cvt_pk_bf16_f32 v32, -v32, -v36
ds_write_addtid_b32 v43 offset:3360
ds_read_b128 v[244:247], v3 offset:33280
v_mfma_f32_16x16x32_bf16 v[84:87], v[12:15], v[164:167], v[84:87]
v_xor_b32 v175, 0x80008000, v175
v_cvt_pk_bf16_f32 v33, -v33, -v37
ds_write_addtid_b32 v32 offset:33024
v_mfma_f32_16x16x32_bf16 v[80:83], v[12:15], v[160:163], v[80:83]
v_cvt_pk_bf16_f32 v34, -v34, -v38
v_cvt_pk_bf16_f32 v35, -v35, -v39
ds_write_addtid_b32 v33 offset:35104
ds_write_addtid_b32 v34 offset:33280
v_mfma_f32_16x16x32_bf16 v[36:39], v[28:31], v[132:135], 0
v_cvt_pk_bf16_f32 v88, v88, v92
ds_write_addtid_b32 v35 offset:35360
ds_read_b128 v[248:251], v3 offset:33536
v_mfma_f32_16x16x32_bf16 v[32:35], v[28:31], v[128:131], 0
v_cvt_pk_bf16_f32 v89, v89, v93
ds_write_addtid_b32 v88 offset:512
v_mfma_f32_16x16x32_bf16 v[44:47], v[20:23], v[100:103], v[36:39]
v_cvt_pk_bf16_f32 v90, v90, v94
v_cvt_pk_bf16_f32 v91, v91, v95
ds_write_addtid_b32 v89 offset:2592
ds_write_addtid_b32 v90 offset:768
s_setprio 1
v_mfma_f32_16x16x32_bf16 v[40:43], v[20:23], v[96:99], v[32:35]
v_cvt_pk_bf16_f32 v80, v80, v84
ds_write_addtid_b32 v91 offset:2848
ds_read_b128 v[252:255], v3 offset:33792
v_mfma_f32_16x16x32_bf16 v[36:39], v[20:23], v[164:167], v[36:39]
v_cvt_pk_bf16_f32 v81, v81, v85
ds_write_addtid_b32 v80 offset:34560
v_mfma_f32_16x16x32_bf16 v[32:35], v[20:23], v[160:163], v[32:35]
v_cvt_pk_bf16_f32 v82, v82, v86
v_cvt_pk_bf16_f32 v83, v83, v87
ds_write_addtid_b32 v81 offset:36640
ds_write_addtid_b32 v82 offset:34816
v_mfma_f32_16x16x32_bf16 v[84:87], v[16:19], v[140:143], 0
v_cvt_pk_bf16_f32 v40, v40, v44
v_cvt_pk_bf16_f32 v41, v41, v45
ds_write_addtid_b32 v83 offset:36896
ds_write_addtid_b32 v40 offset:1536
v_mfma_f32_16x16x32_bf16 v[80:83], v[16:19], v[136:139], 0
v_cvt_pk_bf16_f32 v42, v42, v46
v_cvt_pk_bf16_f32 v43, v43, v47
ds_write_addtid_b32 v41 offset:3616
ds_write_addtid_b32 v42 offset:1792
v_mfma_f32_16x16x32_bf16 v[92:95], v[8:11], v[108:111], v[84:87]
v_cvt_pk_bf16_f32 v32, -v32, -v36
v_cvt_pk_bf16_f32 v33, -v33, -v37
ds_write_addtid_b32 v43 offset:3872
s_setprio 0
v_mfma_f32_16x16x32_bf16 v[88:91], v[8:11], v[104:107], v[80:83]
v_cvt_pk_bf16_f32 v34, -v34, -v38
v_cvt_pk_bf16_f32 v35, -v35, -v39
ds_write_addtid_b32 v32 offset:33536
ds_write_addtid_b32 v33 offset:35616
v_mfma_f32_16x16x32_bf16 v[84:87], v[8:11], v[172:175], v[84:87]
ds_write_addtid_b32 v34 offset:33792
ds_write_addtid_b32 v35 offset:35872
v_mfma_f32_16x16x32_bf16 v[80:83], v[8:11], v[168:171], v[80:83]
v_mfma_f32_16x16x32_bf16 v[36:39], v[24:27], v[140:143], 0
v_xor_b32 v176, 0x80008000, v176
v_cvt_pk_bf16_f32 v88, v88, v92
v_mfma_f32_16x16x32_bf16 v[32:35], v[24:27], v[136:139], 0
v_xor_b32 v177, 0x80008000, v177
v_cvt_pk_bf16_f32 v89, v89, v93
v_mfma_f32_16x16x32_bf16 v[44:47], v[16:19], v[108:111], v[36:39]
v_cvt_pk_bf16_f32 v90, v90, v94
v_cvt_pk_bf16_f32 v91, v91, v95
s_waitcnt vmcnt(0)
s_cmp_lg_u32 s3, 0
s_cbranch_scc1 L_oka
s_mov_b32 s39, 0x40000
L_spina:
v_readfirstlane_b32 s37, v7
s_nop 3
s_cmp_eq_u32 s37, 1
s_cbranch_scc1 L_oka
s_sub_u32 s39, s39, 1
s_cmp_eq_u32 s39, 0
s_cbranch_scc1 L_oka
s_sleep 4
buffer_load_dword v7, off, s[24:27], 0 sc1
s_waitcnt vmcnt(0)
s_branch L_spina
L_oka:
s_waitcnt lgkmcnt(0)
s_barrier
s_mov_b32 m0, s62
s_nop 0
ds_write_addtid_b32 v88 offset:0
ds_write_addtid_b32 v89 offset:2080
s_setprio 3
s_cmp_lg_u32 s3, 0
s_cbranch_scc1 L_w0a
s_mul_i32 s43, s36, 43
s_lshr_b32 s43, s43, 7
s_mul_i32 s43, s43, 116
s_lshl2_add_u32 s43, s36, s43
s_mul_i32 s37, s35, 384
s_add_u32 s43, s43, s37
s_add_u32 s43, s43, 5308416
s_cmp_eq_u32 s3, 0
s_cselect_b32 s37, s59, 0
s_mul_i32 s30, s37, 20992
v_lshl_add_u32 v7, v0, 24, s43
v_mov_b32 v2, 1
buffer_store_dword v2, v7, s[28:31], 0 offen sc1
L_w0a:
v_mfma_f32_16x16x32_bf16 v[40:43], v[16:19], v[104:107], v[32:35]
v_xor_b32 v178, 0x80008000, v178
v_cvt_pk_bf16_f32 v80, v80, v84
ds_write_addtid_b32 v90 offset:256
ds_write_addtid_b32 v91 offset:2336
v_mfma_f32_16x16x32_bf16 v[36:39], v[16:19], v[172:175], v[36:39]
v_xor_b32 v179, 0x80008000, v179
v_cvt_pk_bf16_f32 v81, v81, v85
ds_write_addtid_b32 v80 offset:34048
v_mfma_f32_16x16x32_bf16 v[32:35], v[16:19], v[168:171], v[32:35]
v_cvt_pk_bf16_f32 v82, v82, v86
v_cvt_pk_bf16_f32 v83, v83, v87
ds_write_addtid_b32 v81 offset:36128
ds_write_addtid_b32 v82 offset:34304
v_mfma_f32_16x16x32_bf16 v[84:87], v[20:23], v[140:143], 0
v_xor_b32 v180, 0x80008000, v180
v_cvt_pk_bf16_f32 v40, v40, v44
ds_write_addtid_b32 v83 offset:36384
ds_read_b128 v[96:99], v1 offset:33024
v_mfma_f32_16x16x32_bf16 v[80:83], v[20:23], v[136:139], 0
v_xor_b32 v181, 0x80008000, v181
v_cvt_pk_bf16_f32 v41, v41, v45
ds_write_addtid_b32 v40 offset:1024
ds_read_b128 v[100:103], v1 offset:33280
v_mfma_f32_16x16x32_bf16 v[92:95], v[12:15], v[108:111], v[84:87]
v_cvt_pk_bf16_f32 v42, v42, v46
v_cvt_pk_bf16_f32 v43, v43, v47
ds_write_addtid_b32 v41 offset:3104
ds_write_addtid_b32 v42 offset:1280
s_setprio 2
v_mfma_f32_16x16x32_bf16 v[88:91], v[12:15], v[104:107], v[80:83]
v_xor_b32 v182, 0x80008000, v182
v_cvt_pk_bf16_f32 v32, -v32, -v36
ds_write_addtid_b32 v43 offset:3360
ds_read_b128 v[128:131], v1 offset:33536
v_mfma_f32_16x16x32_bf16 v[84:87], v[12:15], v[172:175], v[84:87]
v_xor_b32 v183, 0x80008000, v183
v_cvt_pk_bf16_f32 v33, -v33, -v37
ds_write_addtid_b32 v32 offset:33024
ds_read_b128 v[132:135], v1 offset:33792
v_mfma_f32_16x16x32_bf16 v[80:83], v[12:15], v[168:171], v[80:83]
v_cvt_pk_bf16_f32 v34, -v34, -v38
v_cvt_pk_bf16_f32 v35, -v35, -v39
ds_write_addtid_b32 v33 offset:35104
ds_write_addtid_b32 v34 offset:33280
v_mfma_f32_16x16x32_bf16 v[36:39], v[28:31], v[140:143], 0
v_cvt_pk_bf16_f32 v88, v88, v92
ds_write_addtid_b32 v35 offset:35360
ds_read_b128 v[64:67], v1 offset:0
v_mfma_f32_16x16x32_bf16 v[32:35], v[28:31], v[136:139], 0
v_cvt_pk_bf16_f32 v89, v89, v93
ds_write_addtid_b32 v88 offset:512
ds_read_b128 v[68:71], v1 offset:256
v_mfma_f32_16x16x32_bf16 v[44:47], v[20:23], v[108:111], v[36:39]
v_cvt_pk_bf16_f32 v90, v90, v94
v_cvt_pk_bf16_f32 v91, v91, v95
ds_write_addtid_b32 v89 offset:2592
ds_write_addtid_b32 v90 offset:768
s_setprio 1
v_mfma_f32_16x16x32_bf16 v[40:43], v[20:23], v[104:107], v[32:35]
v_cvt_pk_bf16_f32 v80, v80, v84
ds_write_addtid_b32 v91 offset:2848
ds_read_b128 v[72:75], v1 offset:512
v_mfma_f32_16x16x32_bf16 v[36:39], v[20:23], v[172:175], v[36:39]
v_cvt_pk_bf16_f32 v81, v81, v85
ds_write_addtid_b32 v80 offset:34560
ds_read_b128 v[76:79], v1 offset:768
v_mfma_f32_16x16x32_bf16 v[32:35], v[20:23], v[168:171], v[32:35]
v_cvt_pk_bf16_f32 v82, v82, v86
v_cvt_pk_bf16_f32 v83, v83, v87
ds_write_addtid_b32 v81 offset:36640
ds_write_addtid_b32 v82 offset:34816
v_mfma_f32_16x16x32_bf16 v[84:87], v[16:19], v[148:151], 0
v_and_b32 v2, 1, v0
v_cvt_pk_bf16_f32 v40, v40, v44
v_cvt_pk_bf16_f32 v41, v41, v45
ds_write_addtid_b32 v83 offset:36896
ds_write_addtid_b32 v40 offset:1536
v_mfma_f32_16x16x32_bf16 v[80:83], v[16:19], v[144:147], 0
v_mul_u32_u24 v2, 2080, v2
v_cvt_pk_bf16_f32 v42, v42, v46
v_cvt_pk_bf16_f32 v43, v43, v47
ds_write_addtid_b32 v41 offset:3616
ds_write_addtid_b32 v42 offset:1792
v_mfma_f32_16x16x32_bf16 v[92:95], v[8:11], v[116:119], v[84:87]
v_cvt_pk_bf16_f32 v32, -v32, -v36
v_cvt_pk_bf16_f32 v33, -v33, -v37
ds_write_addtid_b32 v43 offset:3872
s_setprio 0
v_mfma_f32_16x16x32_bf16 v[88:91], v[8:11], v[112:115], v[80:83]
v_bfe_u32 v7, v0, 1, 1
v_cvt_pk_bf16_f32 v34, -v34, -v38
v_cvt_pk_bf16_f32 v35, -v35, -v39
ds_write_addtid_b32 v32 offset:33536
ds_write_addtid_b32 v33 offset:35616
v_mfma_f32_16x16x32_bf16 v[84:87], v[8:11], v[180:183], v[84:87]
v_lshl_add_u32 v2, v7, 8, v2
ds_write_addtid_b32 v34 offset:33792
ds_write_addtid_b32 v35 offset:35872
v_mfma_f32_16x16x32_bf16 v[80:83], v[8:11], v[176:179], v[80:83]
v_mfma_f32_16x16x32_bf16 v[36:39], v[24:27], v[148:151], 0
v_xor_b32 v184, 0x80008000, v184
v_cvt_pk_bf16_f32 v88, v88, v92
v_mfma_f32_16x16x32_bf16 v[32:35], v[24:27], v[144:147], 0
v_xor_b32 v185, 0x80008000, v185
v_cvt_pk_bf16_f32 v89, v89, v93
v_mfma_f32_16x16x32_bf16 v[44:47], v[16:19], v[116:119], v[36:39]
v_cvt_pk_bf16_f32 v90, v90, v94
v_cvt_pk_bf16_f32 v91, v91, v95
s_waitcnt lgkmcnt(0)
s_barrier
s_add_u32 m0, s62, 66048
s_nop 0
ds_write_addtid_b32 v88 offset:33024
ds_write_addtid_b32 v89 offset:35104
s_setprio 3
v_mfma_f32_16x16x32_bf16 v[40:43], v[16:19], v[112:115], v[32:35]
v_xor_b32 v186, 0x80008000, v186
v_cvt_pk_bf16_f32 v80, v80, v84
ds_write_addtid_b32 v90 offset:33280
ds_write_addtid_b32 v91 offset:35360
v_mfma_f32_16x16x32_bf16 v[36:39], v[16:19], v[180:183], v[36:39]
v_xor_b32 v187, 0x80008000, v187
v_cvt_pk_bf16_f32 v81, v81, v85
ds_write_addtid_b32 v80 offset:1024
v_mfma_f32_16x16x32_bf16 v[32:35], v[16:19], v[176:179], v[32:35]
v_cvt_pk_bf16_f32 v82, v82, v86
v_cvt_pk_bf16_f32 v83, v83, v87
ds_write_addtid_b32 v81 offset:3104
ds_write_addtid_b32 v82 offset:1280
v_mfma_f32_16x16x32_bf16 v[84:87], v[20:23], v[148:151], 0
v_xor_b32 v188, 0x80008000, v188
v_cvt_pk_bf16_f32 v40, v40, v44
ds_write_addtid_b32 v83 offset:3360
ds_read_b128 v[160:163], v3 offset:0
v_mfma_f32_16x16x32_bf16 v[80:83], v[20:23], v[144:147], 0
v_xor_b32 v189, 0x80008000, v189
v_cvt_pk_bf16_f32 v41, v41, v45
ds_write_addtid_b32 v40 offset:34048
ds_read_b128 v[164:167], v3 offset:256
v_mfma_f32_16x16x32_bf16 v[92:95], v[12:15], v[116:119], v[84:87]
v_cvt_pk_bf16_f32 v42, v42, v46
v_cvt_pk_bf16_f32 v43, v43, v47
ds_write_addtid_b32 v41 offset:36128
ds_write_addtid_b32 v42 offset:34304
s_setprio 2
v_mfma_f32_16x16x32_bf16 v[88:91], v[12:15], v[112:115], v[80:83]
v_xor_b32 v190, 0x80008000, v190
v_cvt_pk_bf16_f32 v32, -v32, -v36
ds_write_addtid_b32 v43 offset:36384
ds_read_b128 v[104:107], v3 offset:512
v_mfma_f32_16x16x32_bf16 v[84:87], v[12:15], v[180:183], v[84:87]
v_xor_b32 v191, 0x80008000, v191
v_cvt_pk_bf16_f32 v33, -v33, -v37
ds_write_addtid_b32 v32 offset:0
ds_read_b128 v[108:111], v3 offset:768
v_mfma_f32_16x16x32_bf16 v[80:83], v[12:15], v[176:179], v[80:83]
v_cvt_pk_bf16_f32 v34, -v34, -v38
v_cvt_pk_bf16_f32 v35, -v35, -v39
ds_write_addtid_b32 v33 offset:2080
ds_write_addtid_b32 v34 offset:256
v_mfma_f32_16x16x32_bf16 v[36:39], v[28:31], v[148:151], 0
v_bfe_u32 v7, v0, 2, 2
v_cvt_pk_bf16_f32 v88, v88, v92
ds_write_addtid_b32 v35 offset:2336
ds_read_b128 v[136:139], v3 offset:33024
v_mfma_f32_16x16x32_bf16 v[32:35], v[28:31], v[144:147], 0
v_lshl_add_u32 v2, v7, 6, v2
v_cvt_pk_bf16_f32 v89, v89, v93
ds_write_addtid_b32 v88 offset:33536
ds_read_b128 v[140:143], v3 offset:33280
v_mfma_f32_16x16x32_bf16 v[44:47], v[20:23], v[116:119], v[36:39]
v_cvt_pk_bf16_f32 v90, v90, v94
v_cvt_pk_bf16_f32 v91, v91, v95
ds_write_addtid_b32 v89 offset:35616
ds_write_addtid_b32 v90 offset:33792
s_setprio 1
v_mfma_f32_16x16x32_bf16 v[40:43], v[20:23], v[112:115], v[32:35]
v_bfe_u32 v7, v0, 4, 1
v_cvt_pk_bf16_f32 v80, v80, v84
ds_write_addtid_b32 v91 offset:35872
ds_read_b128 v[168:171], v3 offset:33536
v_mfma_f32_16x16x32_bf16 v[36:39], v[20:23], v[180:183], v[36:39]
v_lshl_add_u32 v2, v7, 3, v2
v_cvt_pk_bf16_f32 v81, v81, v85
ds_write_addtid_b32 v80 offset:1536
ds_read_b128 v[172:175], v3 offset:33792
v_mfma_f32_16x16x32_bf16 v[32:35], v[20:23], v[176:179], v[32:35]
v_cvt_pk_bf16_f32 v82, v82, v86
v_cvt_pk_bf16_f32 v83, v83, v87
ds_write_addtid_b32 v81 offset:3616
ds_write_addtid_b32 v82 offset:1792
v_mfma_f32_16x16x32_bf16 v[84:87], v[16:19], v[156:159], 0
v_lshrrev_b32 v7, 2, v0
v_cvt_pk_bf16_f32 v40, v40, v44
v_cvt_pk_bf16_f32 v41, v41, v45
ds_write_addtid_b32 v83 offset:3872
ds_write_addtid_b32 v40 offset:34560
v_mfma_f32_16x16x32_bf16 v[80:83], v[16:19], v[152:155], 0
v_xor_b32 v7, v7, v0
v_cvt_pk_bf16_f32 v42, v42, v46
v_cvt_pk_bf16_f32 v43, v43, v47
ds_write_addtid_b32 v41 offset:36640
ds_write_addtid_b32 v42 offset:34816
v_mfma_f32_16x16x32_bf16 v[92:95], v[8:11], v[124:127], v[84:87]
v_cvt_pk_bf16_f32 v32, -v32, -v36
v_cvt_pk_bf16_f32 v33, -v33, -v37
ds_write_addtid_b32 v43 offset:36896
s_setprio 0
v_mfma_f32_16x16x32_bf16 v[88:91], v[8:11], v[120:123], v[80:83]
v_and_b32 v7, 8, v7
v_cvt_pk_bf16_f32 v34, -v34, -v38
v_cvt_pk_bf16_f32 v35, -v35, -v39
ds_write_addtid_b32 v32 offset:512
ds_write_addtid_b32 v33 offset:2592
v_mfma_f32_16x16x32_bf16 v[84:87], v[8:11], v[188:191], v[84:87]
v_lshl_add_u32 v2, v7, 1, v2
ds_write_addtid_b32 v34 offset:768
ds_write_addtid_b32 v35 offset:2848
v_mfma_f32_16x16x32_bf16 v[80:83], v[8:11], v[184:187], v[80:83]
s_cmp_lg_u32 s3, 0
s_cbranch_scc1 L_w0p
s_cmp_eq_u32 s3, 0
s_cselect_b32 s30, 5373952, 0
v_min_u32 v7, 53, v0
v_mul_u32_u24 v7, 128, v7
v_add_u32 v7, 5308416, v7
buffer_load_dwordx3 v[176:178], v7, s[28:31], 0 offen sc1
L_w0p:
v_mfma_f32_16x16x32_bf16 v[36:39], v[24:27], v[156:159], 0
v_xor_b32 v60, 0x80008000, v60
v_cvt_pk_bf16_f32 v88, v88, v92
v_mfma_f32_16x16x32_bf16 v[32:35], v[24:27], v[152:155], 0
v_xor_b32 v61, 0x80008000, v61
v_cvt_pk_bf16_f32 v89, v89, v93
v_mfma_f32_16x16x32_bf16 v[44:47], v[16:19], v[124:127], v[36:39]
v_cvt_pk_bf16_f32 v90, v90, v94
v_cvt_pk_bf16_f32 v91, v91, v95
s_waitcnt lgkmcnt(0)
s_barrier
s_mov_b32 m0, s62
s_nop 0
ds_write_addtid_b32 v88 offset:0
ds_write_addtid_b32 v89 offset:2080
s_setprio 3
v_mfma_f32_16x16x32_bf16 v[40:43], v[16:19], v[120:123], v[32:35]
v_xor_b32 v62, 0x80008000, v62
v_cvt_pk_bf16_f32 v80, v80, v84
ds_write_addtid_b32 v90 offset:256
ds_write_addtid_b32 v91 offset:2336
ds_read_b128 v[112:115], v1 offset:33024
v_mfma_f32_16x16x32_bf16 v[36:39], v[16:19], v[188:191], v[36:39]
v_xor_b32 v63, 0x80008000, v63
v_cvt_pk_bf16_f32 v81, v81, v85
ds_write_addtid_b32 v80 offset:34048
ds_read_b128 v[116:119], v1 offset:33280
s_setprio 2
v_mfma_f32_16x16x32_bf16 v[32:35], v[16:19], v[184:187], v[32:35]
v_cvt_pk_bf16_f32 v82, v82, v86
v_cvt_pk_bf16_f32 v83, v83, v87
ds_write_addtid_b32 v81 offset:36128
ds_write_addtid_b32 v82 offset:34304
v_mfma_f32_16x16x32_bf16 v[84:87], v[20:23], v[156:159], 0
v_cvt_pk_bf16_f32 v40, v40, v44
ds_write_addtid_b32 v83 offset:36384
ds_read_b128 v[144:147], v1 offset:33536
v_mfma_f32_16x16x32_bf16 v[80:83], v[20:23], v[152:155], 0
v_cvt_pk_bf16_f32 v41, v41, v45
ds_write_addtid_b32 v40 offset:1024
ds_read_b128 v[148:151], v1 offset:33792
s_setprio 1
v_mfma_f32_16x16x32_bf16 v[92:95], v[12:15], v[124:127], v[84:87]
v_cvt_pk_bf16_f32 v42, v42, v46
v_cvt_pk_bf16_f32 v43, v43, v47
ds_write_addtid_b32 v41 offset:3104
ds_write_addtid_b32 v42 offset:1280
v_mfma_f32_16x16x32_bf16 v[88:91], v[12:15], v[120:123], v[80:83]
v_cvt_pk_bf16_f32 v32, -v32, -v36
ds_write_addtid_b32 v43 offset:3360
v_mfma_f32_16x16x32_bf16 v[84:87], v[12:15], v[188:191], v[84:87]
v_cvt_pk_bf16_f32 v33, -v33, -v37
ds_write_addtid_b32 v32 offset:33024
s_setprio 0
v_mfma_f32_16x16x32_bf16 v[80:83], v[12:15], v[184:187], v[80:83]
v_cvt_pk_bf16_f32 v34, -v34, -v38
v_cvt_pk_bf16_f32 v35, -v35, -v39
ds_write_addtid_b32 v33 offset:35104
ds_write_addtid_b32 v34 offset:33280
v_mfma_f32_16x16x32_bf16 v[36:39], v[28:31], v[156:159], 0
v_cvt_pk_bf16_f32 v88, v88, v92
ds_write_addtid_b32 v35 offset:35360
v_mfma_f32_16x16x32_bf16 v[32:35], v[28:31], v[152:155], 0
v_cvt_pk_bf16_f32 v89, v89, v93
s_waitcnt vmcnt(0)
s_cmp_lg_u32 s3, 0
s_cbranch_scc1 L_okb
s_mov_b32 s39, 0x40000
L_spinb:
v_and_b32 v176, v176, v177
v_and_b32 v176, v176, v178
v_cmp_ne_u32 vcc, 1, v176
s_nop 3
s_cmp_eq_u64 vcc, 0
s_cbranch_scc1 L_okb
s_sub_u32 s39, s39, 1
s_cmp_eq_u32 s39, 0
s_cbranch_scc1 L_okb
s_sleep 4
buffer_load_dwordx3 v[176:178], v7, s[28:31], 0 offen sc1
s_waitcnt vmcnt(0)
s_branch L_spinb
L_okb:
s_waitcnt lgkmcnt(7)
s_barrier
ds_write_addtid_b32 v88 offset:512
s_setprio 3
buffer_load_dwordx4 v[176:179], v4, s[12:15], s40 offen offset:0 sc1
v_mfma_f32_16x16x32_bf16 v[44:47], v[20:23], v[124:127], v[36:39]
v_cvt_pk_bf16_f32 v90, v90, v94
v_cvt_pk_bf16_f32 v91, v91, v95
ds_write_addtid_b32 v89 offset:2592
ds_write_addtid_b32 v90 offset:768
v_mfma_f32_16x16x32_bf16 v[40:43], v[20:23], v[120:123], v[32:35]
v_cvt_pk_bf16_f32 v80, v80, v84
ds_write_addtid_b32 v91 offset:2848
buffer_load_dwordx4 v[180:183], v4, s[12:15], s40 offen offset:1024 sc1
v_mfma_f32_16x16x32_bf16 v[36:39], v[20:23], v[188:191], v[36:39]
v_cvt_pk_bf16_f32 v81, v81, v85
ds_write_addtid_b32 v80 offset:34560
v_mfma_f32_16x16x32_bf16 v[32:35], v[20:23], v[184:187], v[32:35]
v_cvt_pk_bf16_f32 v82, v82, v86
v_cvt_pk_bf16_f32 v83, v83, v87
ds_write_addtid_b32 v81 offset:36640
ds_write_addtid_b32 v82 offset:34816
v_mfma_f32_16x16x32_bf16 v[84:87], v[56:59], v[24:27], 0
v_cvt_pk_bf16_f32 v40, v40, v44
v_cvt_pk_bf16_f32 v41, v41, v45
ds_write_addtid_b32 v83 offset:36896
ds_write_addtid_b32 v40 offset:1536
buffer_load_dwordx4 v[120:123], v4, s[12:15], s40 offen offset:2048 sc1
v_mfma_f32_16x16x32_bf16 v[80:83], v[56:59], v[16:19], 0
v_cvt_pk_bf16_f32 v42, v42, v46
v_cvt_pk_bf16_f32 v43, v43, v47
ds_write_addtid_b32 v41 offset:3616
ds_write_addtid_b32 v42 offset:1792
s_setprio 2
v_mfma_f32_16x16x32_bf16 v[92:95], v[52:55], v[16:19], v[84:87]
v_cvt_pk_bf16_f32 v32, -v32, -v36
v_cvt_pk_bf16_f32 v33, -v33, -v37
ds_write_addtid_b32 v43 offset:3872
buffer_load_dwordx4 v[124:127], v4, s[12:15], s40 offen offset:3072 sc1
v_mfma_f32_16x16x32_bf16 v[88:91], v[52:55], v[8:11], v[80:83]
v_cvt_pk_bf16_f32 v34, -v34, -v38
v_cvt_pk_bf16_f32 v35, -v35, -v39
ds_write_addtid_b32 v32 offset:33536
ds_write_addtid_b32 v33 offset:35616
v_mfma_f32_16x16x32_bf16 v[84:87], v[60:63], v[16:19], v[84:87]
ds_write_addtid_b32 v34 offset:33792
ds_write_addtid_b32 v35 offset:35872
buffer_load_dwordx4 v[152:155], v4, s[12:15], s41 offen offset:0 sc1
v_mfma_f32_16x16x32_bf16 v[80:83], v[60:63], v[8:11], v[80:83]
s_add_u32 s38, s62, 99072
v_add_u32 v1, s38, v2
s_add_u32 s38, s63, 132096
v_add_u32 v2, s38, v2
v_mfma_f32_16x16x32_bf16 v[36:39], v[56:59], v[28:31], 0
v_cvt_pk_bf16_f32 v92, v92, v93
v_cvt_pk_bf16_f32 v93, v94, v95
buffer_load_dwordx4 v[156:159], v4, s[12:15], s41 offen offset:1024 sc1
v_mfma_f32_16x16x32_bf16 v[32:35], v[56:59], v[20:23], 0
v_cvt_pk_bf16_f32 v88, v88, v89
v_cvt_pk_bf16_f32 v89, v90, v91
s_setprio 1
v_mfma_f32_16x16x32_bf16 v[44:47], v[52:55], v[20:23], v[36:39]
v_cvt_pk_bf16_f32 v84, -v84, -v85
v_cvt_pk_bf16_f32 v85, -v86, -v87
ds_write_b64 v1, v[92:93] offset:1056
buffer_load_dwordx4 v[184:187], v4, s[12:15], s41 offen offset:2048 sc1
v_mfma_f32_16x16x32_bf16 v[40:43], v[52:55], v[12:15], v[32:35]
v_cvt_pk_bf16_f32 v80, v80, v81
v_cvt_pk_bf16_f32 v81, v82, v83
ds_write_b64 v1, v[88:89] offset:32
v_mfma_f32_16x16x32_bf16 v[36:39], v[60:63], v[20:23], v[36:39]
ds_write_b64 v2, v[84:85] offset:0
buffer_load_dwordx4 v[188:191], v4, s[12:15], s41 offen offset:3072 sc1
v_mfma_f32_16x16x32_bf16 v[32:35], v[60:63], v[12:15], v[32:35]
ds_write_b64 v2, v[80:81] offset:1024
v_mfma_f32_16x16x32_bf16 v[84:87], v[48:51], v[16:19], 0
v_cvt_pk_bf16_f32 v44, v44, v45
v_cvt_pk_bf16_f32 v45, v46, v47
v_mfma_f32_16x16x32_bf16 v[84:87], v[52:55], v[24:27], v[84:87]
v_cvt_pk_bf16_f32 v40, v40, v41
v_cvt_pk_bf16_f32 v41, v42, v43
s_setprio 0
v_mfma_f32_16x16x32_bf16 v[80:83], v[48:51], v[8:11], 0
v_cvt_pk_bf16_f32 v36, -v36, -v37
v_cvt_pk_bf16_f32 v37, -v38, -v39
ds_write_b64 v1, v[44:45] offset:1568
v_mfma_f32_16x16x32_bf16 v[80:83], v[52:55], v[16:19], v[80:83]
v_cvt_pk_bf16_f32 v32, v32, v33
v_cvt_pk_bf16_f32 v33, v34, v35
ds_write_b64 v1, v[40:41] offset:544
v_mfma_f32_16x16x32_bf16 v[92:95], v[48:51], v[20:23], 0
ds_write_b64 v2, v[36:37] offset:512
v_mfma_f32_16x16x32_bf16 v[92:95], v[52:55], v[28:31], v[92:95]
ds_write_b64 v2, v[32:33] offset:1536
v_mfma_f32_16x16x32_bf16 v[88:91], v[48:51], v[12:15], 0
v_cvt_pk_bf16_f32 v80, v80, v81
v_cvt_pk_bf16_f32 v81, v82, v83
v_mfma_f32_16x16x32_bf16 v[88:91], v[52:55], v[20:23], v[88:91]
v_cvt_pk_bf16_f32 v82, v84, v85
v_cvt_pk_bf16_f32 v83, v86, v87
ds_write_b64 v1, v[80:81] offset:0
ds_write_b64 v1, v[82:83] offset:1024
s_nop 3
v_cvt_pk_bf16_f32 v88, v88, v89
v_cvt_pk_bf16_f32 v89, v90, v91
v_cvt_pk_bf16_f32 v90, v92, v93
v_cvt_pk_bf16_f32 v91, v94, v95
ds_write_b64 v1, v[88:89] offset:512
ds_write_b64 v1, v[90:91] offset:1536
buffer_load_dwordx4 v[48:51], v4, s[12:15], s42 offen offset:0 sc1
s_setprio 3
s_waitcnt vmcnt(8)
v_mfma_f32_16x16x32_bf16 v[24:27], v[176:179], v[192:195], 0
v_add_u32 v1, 66048, v3
v_add_u32 v2, 66048, v6
v_mfma_f32_16x16x32_bf16 v[28:31], v[176:179], v[64:67], 0
v_and_b32 v94, 7, v0
v_mul_u32_u24 v94, 4128, v94
v_mfma_f32_16x16x32_bf16 v[32:35], v[176:179], v[96:99], 0
v_bfe_u32 v95, v0, 1, 2
v_mul_u32_u24 v95, 4160, v95
s_add_u32 s40, s40, 9216
s_add_u32 s41, s40, 4096
s_add_u32 s42, s40, 8192
buffer_load_dwordx4 v[176:179], v4, s[12:15], s40 offen offset:0 sc1
s_waitcnt vmcnt(8)
v_mfma_f32_16x16x32_bf16 v[44:47], v[180:183], v[96:99], 0
v_sub_u32 v95, v95, v94
v_and_b32 v94, 1, v0
v_mfma_f32_16x16x32_bf16 v[40:43], v[180:183], v[64:67], 0
v_lshl_add_u32 v95, v94, 5, v95
v_add_u32 v95, 33024, v95
v_mfma_f32_16x16x32_bf16 v[36:39], v[180:183], v[192:195], 0
v_add_u32 v94, v95, v5
s_waitcnt lgkmcnt(0)
s_barrier
buffer_load_dwordx4 v[180:183], v4, s[12:15], s40 offen offset:1024 sc1
s_waitcnt vmcnt(8)
v_mfma_f32_16x16x32_bf16 v[24:27], v[120:123], v[208:211], v[24:27]
ds_read_b128 v[80:83], v1 offset:0
ds_read_b128 v[84:87], v3 offset:0
v_mfma_f32_16x16x32_bf16 v[28:31], v[120:123], v[160:163], v[28:31]
ds_read_b128 v[88:91], v3 offset:33024
ds_read_b128 v[52:55], v5 offset:0
v_mfma_f32_16x16x32_bf16 v[32:35], v[120:123], v[136:139], v[32:35]
ds_read_b128 v[56:59], v5 offset:32
ds_read_b128 v[60:63], v94 offset:0
buffer_load_dwordx4 v[120:123], v4, s[12:15], s40 offen offset:2048 sc1
s_waitcnt vmcnt(8)
v_mfma_f32_16x16x32_bf16 v[44:47], v[124:127], v[136:139], v[44:47]
v_add_u32 v95, 99072, v95
v_add_u32 v7, v95, v6
v_mfma_f32_16x16x32_bf16 v[40:43], v[124:127], v[160:163], v[40:43]
v_and_b32 v93, 8, v0
v_cmp_eq_u32 vcc, 0, v93
v_mfma_f32_16x16x32_bf16 v[36:39], v[124:127], v[208:211], v[36:39]
s_nop 0
v_cndmask_b32 v92, 1.0, -1.0, vcc
v_and_b32 v93, 40, v0
buffer_load_dwordx4 v[124:127], v4, s[12:15], s40 offen offset:3072 sc1
s_waitcnt vmcnt(8)
v_mfma_f32_16x16x32_bf16 v[24:27], v[152:155], v[224:227], v[24:27]
v_cmp_eq_u32 vcc, 32, v93
v_mov_b32 v95, 0x80008000
v_mfma_f32_16x16x32_bf16 v[28:31], v[152:155], v[112:115], v[28:31]
v_cndmask_b32 v93, 0, v95, vcc
s_waitcnt lgkmcnt(2)
v_xor_b32 v52, v93, v52
v_mfma_f32_16x16x32_bf16 v[32:35], v[152:155], v[80:83], v[32:35]
v_xor_b32 v53, v93, v53
v_xor_b32 v54, v93, v54
buffer_load_dwordx4 v[152:155], v4, s[12:15], s41 offen offset:0 sc1
s_waitcnt vmcnt(8)
v_mfma_f32_16x16x32_bf16 v[44:47], v[156:159], v[80:83], v[44:47]
v_xor_b32 v55, v93, v55
s_waitcnt lgkmcnt(1)
v_xor_b32 v56, v93, v56
v_mfma_f32_16x16x32_bf16 v[40:43], v[156:159], v[112:115], v[40:43]
v_xor_b32 v57, v93, v57
v_xor_b32 v58, v93, v58
v_mfma_f32_16x16x32_bf16 v[36:39], v[156:159], v[224:227], v[36:39]
v_xor_b32 v59, v93, v59
s_waitcnt lgkmcnt(0)
v_xor_b32 v60, v93, v60
buffer_load_dwordx4 v[156:159], v4, s[12:15], s41 offen offset:1024 sc1
s_waitcnt vmcnt(8)
v_mfma_f32_16x16x32_bf16 v[24:27], v[184:187], v[240:243], v[24:27]
v_xor_b32 v61, v93, v61
v_xor_b32 v62, v93, v62
v_mfma_f32_16x16x32_bf16 v[28:31], v[184:187], v[84:87], v[28:31]
v_xor_b32 v63, v93, v63
v_mfma_f32_16x16x32_bf16 v[32:35], v[184:187], v[88:91], v[32:35]
buffer_load_dwordx4 v[184:187], v4, s[12:15], s41 offen offset:2048 sc1
s_waitcnt vmcnt(8)
v_mfma_f32_16x16x32_bf16 v[44:47], v[188:191], v[88:91], v[44:47]
v_mfma_f32_16x16x32_bf16 v[40:43], v[188:191], v[84:87], v[40:43]
v_mfma_f32_16x16x32_bf16 v[36:39], v[188:191], v[240:243], v[36:39]
buffer_load_dwordx4 v[188:191], v4, s[12:15], s41 offen offset:3072 sc1
s_waitcnt vmcnt(8)
v_mfma_f32_16x16x32_bf16 v[24:27], v[48:51], v[52:55], v[24:27]
v_mfma_f32_16x16x32_bf16 v[28:31], v[48:51], v[56:59], v[28:31]
v_mfma_f32_16x16x32_bf16 v[32:35], v[48:51], v[60:63], v[32:35]
buffer_load_dwordx4 v[48:51], v4, s[12:15], s42 offen offset:0 sc1
s_nop 4
v_fmac_f32_dpp v24, v36, v92 row_ror:8 row_mask:0xf bank_mask:0xf
v_fmac_f32_dpp v25, v37, v92 row_ror:8 row_mask:0xf bank_mask:0xf
v_fmac_f32_dpp v26, v38, v92 row_ror:8 row_mask:0xf bank_mask:0xf
v_fmac_f32_dpp v27, v39, v92 row_ror:8 row_mask:0xf bank_mask:0xf
v_cvt_pk_bf16_f32 v24, v24, v25
v_cvt_pk_bf16_f32 v25, v26, v27
ds_write_b32 v6, v24 offset:0
ds_write_b32 v6, v25 offset:8
v_fmac_f32_dpp v28, v40, v92 row_ror:8 row_mask:0xf bank_mask:0xf
v_fmac_f32_dpp v29, v41, v92 row_ror:8 row_mask:0xf bank_mask:0xf
v_fmac_f32_dpp v30, v42, v92 row_ror:8 row_mask:0xf bank_mask:0xf
v_fmac_f32_dpp v31, v43, v92 row_ror:8 row_mask:0xf bank_mask:0xf
v_cvt_pk_bf16_f32 v28, v28, v29
v_cvt_pk_bf16_f32 v29, v30, v31
ds_write_b32 v6, v28 offset:32
ds_write_b32 v6, v29 offset:40
v_fmac_f32_dpp v32, v44, v92 row_ror:8 row_mask:0xf bank_mask:0xf
v_fmac_f32_dpp v33, v45, v92 row_ror:8 row_mask:0xf bank_mask:0xf
v_fmac_f32_dpp v34, v46, v92 row_ror:8 row_mask:0xf bank_mask:0xf
v_fmac_f32_dpp v35, v47, v92 row_ror:8 row_mask:0xf bank_mask:0xf
v_cvt_pk_bf16_f32 v32, v32, v33
v_cvt_pk_bf16_f32 v33, v34, v35
ds_write_b32 v2, v32 offset:33024
ds_write_b32 v2, v33 offset:33032
s_waitcnt vmcnt(8)
v_mfma_f32_16x16x32_bf16 v[24:27], v[176:179], v[192:195], 0
v_mfma_f32_16x16x32_bf16 v[28:31], v[176:179], v[64:67], 0
v_mfma_f32_16x16x32_bf16 v[32:35], v[176:179], v[96:99], 0
s_add_u32 s40, s40, 9216
s_add_u32 s41, s40, 4096
s_add_u32 s42, s40, 8192
buffer_load_dwordx4 v[176:179], v4, s[12:15], s40 offen offset:0 sc1
s_waitcnt vmcnt(8)
v_mfma_f32_16x16x32_bf16 v[44:47], v[180:183], v[96:99], 0
v_mfma_f32_16x16x32_bf16 v[40:43], v[180:183], v[64:67], 0
v_mfma_f32_16x16x32_bf16 v[36:39], v[180:183], v[192:195], 0
buffer_load_dwordx4 v[180:183], v4, s[12:15], s40 offen offset:1024 sc1
s_waitcnt vmcnt(8)
v_mfma_f32_16x16x32_bf16 v[24:27], v[120:123], v[208:211], v[24:27]
v_mfma_f32_16x16x32_bf16 v[28:31], v[120:123], v[160:163], v[28:31]
v_mfma_f32_16x16x32_bf16 v[32:35], v[120:123], v[136:139], v[32:35]
buffer_load_dwordx4 v[120:123], v4, s[12:15], s40 offen offset:2048 sc1
s_waitcnt vmcnt(8)
v_mfma_f32_16x16x32_bf16 v[44:47], v[124:127], v[136:139], v[44:47]
v_mfma_f32_16x16x32_bf16 v[40:43], v[124:127], v[160:163], v[40:43]
v_mfma_f32_16x16x32_bf16 v[36:39], v[124:127], v[208:211], v[36:39]
buffer_load_dwordx4 v[124:127], v4, s[12:15], s40 offen offset:3072 sc1
s_waitcnt vmcnt(8)
v_mfma_f32_16x16x32_bf16 v[24:27], v[152:155], v[224:227], v[24:27]
v_mfma_f32_16x16x32_bf16 v[28:31], v[152:155], v[112:115], v[28:31]
v_mfma_f32_16x16x32_bf16 v[32:35], v[152:155], v[80:83], v[32:35]
buffer_load_dwordx4 v[152:155], v4, s[12:15], s41 offen offset:0 sc1
s_waitcnt vmcnt(8)
v_mfma_f32_16x16x32_bf16 v[44:47], v[156:159], v[80:83], v[44:47]
v_mfma_f32_16x16x32_bf16 v[40:43], v[156:159], v[112:115], v[40:43]
v_mfma_f32_16x16x32_bf16 v[36:39], v[156:159], v[224:227], v[36:39]
buffer_load_dwordx4 v[156:159], v4, s[12:15], s41 offen offset:1024 sc1
s_waitcnt vmcnt(8)
v_mfma_f32_16x16x32_bf16 v[24:27], v[184:187], v[240:243], v[24:27]
v_mfma_f32_16x16x32_bf16 v[28:31], v[184:187], v[84:87], v[28:31]
v_mfma_f32_16x16x32_bf16 v[32:35], v[184:187], v[88:91], v[32:35]
buffer_load_dwordx4 v[184:187], v4, s[12:15], s41 offen offset:2048 sc1
s_waitcnt vmcnt(8)
v_mfma_f32_16x16x32_bf16 v[44:47], v[188:191], v[88:91], v[44:47]
v_mfma_f32_16x16x32_bf16 v[40:43], v[188:191], v[84:87], v[40:43]
v_mfma_f32_16x16x32_bf16 v[36:39], v[188:191], v[240:243], v[36:39]
buffer_load_dwordx4 v[188:191], v4, s[12:15], s41 offen offset:3072 sc1
s_waitcnt vmcnt(8)
v_mfma_f32_16x16x32_bf16 v[24:27], v[48:51], v[52:55], v[24:27]
v_mfma_f32_16x16x32_bf16 v[28:31], v[48:51], v[56:59], v[28:31]
v_mfma_f32_16x16x32_bf16 v[32:35], v[48:51], v[60:63], v[32:35]
buffer_load_dwordx4 v[48:51], v4, s[12:15], s42 offen offset:0 sc1
s_nop 4
v_fmac_f32_dpp v24, v36, v92 row_ror:8 row_mask:0xf bank_mask:0xf
v_fmac_f32_dpp v25, v37, v92 row_ror:8 row_mask:0xf bank_mask:0xf
v_fmac_f32_dpp v26, v38, v92 row_ror:8 row_mask:0xf bank_mask:0xf
v_fmac_f32_dpp v27, v39, v92 row_ror:8 row_mask:0xf bank_mask:0xf
v_cvt_pk_bf16_f32 v24, v24, v25
v_cvt_pk_bf16_f32 v25, v26, v27
ds_write_b32 v6, v24 offset:33024
ds_write_b32 v6, v25 offset:33032
v_fmac_f32_dpp v28, v40, v92 row_ror:8 row_mask:0xf bank_mask:0xf
v_fmac_f32_dpp v29, v41, v92 row_ror:8 row_mask:0xf bank_mask:0xf
v_fmac_f32_dpp v30, v42, v92 row_ror:8 row_mask:0xf bank_mask:0xf
v_fmac_f32_dpp v31, v43, v92 row_ror:8 row_mask:0xf bank_mask:0xf
v_cvt_pk_bf16_f32 v28, v28, v29
v_cvt_pk_bf16_f32 v29, v30, v31
ds_write_b32 v6, v28 offset:33056
ds_write_b32 v6, v29 offset:33064
v_fmac_f32_dpp v32, v44, v92 row_ror:8 row_mask:0xf bank_mask:0xf
v_fmac_f32_dpp v33, v45, v92 row_ror:8 row_mask:0xf bank_mask:0xf
v_fmac_f32_dpp v34, v46, v92 row_ror:8 row_mask:0xf bank_mask:0xf
v_fmac_f32_dpp v35, v47, v92 row_ror:8 row_mask:0xf bank_mask:0xf
v_cvt_pk_bf16_f32 v32, v32, v33
v_cvt_pk_bf16_f32 v33, v34, v35
ds_write_b32 v2, v32 offset:33056
ds_write_b32 v2, v33 offset:33064
s_waitcnt vmcnt(8)
v_mfma_f32_16x16x32_bf16 v[24:27], v[176:179], v[192:195], 0
v_mfma_f32_16x16x32_bf16 v[28:31], v[176:179], v[64:67], 0
v_mfma_f32_16x16x32_bf16 v[32:35], v[176:179], v[96:99], 0
s_add_u32 s40, s60, 110592
s_add_u32 s41, s40, 4096
s_add_u32 s42, s40, 8192
buffer_load_dwordx4 v[176:179], v4, s[12:15], s40 offen offset:0 sc1
s_waitcnt vmcnt(8)
v_mfma_f32_16x16x32_bf16 v[44:47], v[180:183], v[96:99], 0
v_mfma_f32_16x16x32_bf16 v[40:43], v[180:183], v[64:67], 0
v_mfma_f32_16x16x32_bf16 v[36:39], v[180:183], v[192:195], 0
buffer_load_dwordx4 v[180:183], v4, s[12:15], s40 offen offset:1024 sc1
s_waitcnt vmcnt(8)
v_mfma_f32_16x16x32_bf16 v[24:27], v[120:123], v[208:211], v[24:27]
v_mfma_f32_16x16x32_bf16 v[28:31], v[120:123], v[160:163], v[28:31]
v_mfma_f32_16x16x32_bf16 v[32:35], v[120:123], v[136:139], v[32:35]
buffer_load_dwordx4 v[120:123], v4, s[12:15], s40 offen offset:2048 sc1
s_waitcnt vmcnt(8)
v_mfma_f32_16x16x32_bf16 v[44:47], v[124:127], v[136:139], v[44:47]
v_mfma_f32_16x16x32_bf16 v[40:43], v[124:127], v[160:163], v[40:43]
v_mfma_f32_16x16x32_bf16 v[36:39], v[124:127], v[208:211], v[36:39]
buffer_load_dwordx4 v[124:127], v4, s[12:15], s40 offen offset:3072 sc1
s_waitcnt vmcnt(8)
v_mfma_f32_16x16x32_bf16 v[24:27], v[152:155], v[224:227], v[24:27]
v_mfma_f32_16x16x32_bf16 v[28:31], v[152:155], v[112:115], v[28:31]
v_mfma_f32_16x16x32_bf16 v[32:35], v[152:155], v[80:83], v[32:35]
buffer_load_dwordx4 v[152:155], v4, s[12:15], s41 offen offset:0 sc1
s_waitcnt vmcnt(8)
v_mfma_f32_16x16x32_bf16 v[44:47], v[156:159], v[80:83], v[44:47]
v_mfma_f32_16x16x32_bf16 v[40:43], v[156:159], v[112:115], v[40:43]
v_mfma_f32_16x16x32_bf16 v[36:39], v[156:159], v[224:227], v[36:39]
buffer_load_dwordx4 v[156:159], v4, s[12:15], s41 offen offset:1024 sc1
s_waitcnt vmcnt(8)
v_mfma_f32_16x16x32_bf16 v[24:27], v[184:187], v[240:243], v[24:27]
v_mfma_f32_16x16x32_bf16 v[28:31], v[184:187], v[84:87], v[28:31]
v_mfma_f32_16x16x32_bf16 v[32:35], v[184:187], v[88:91], v[32:35]
buffer_load_dwordx4 v[184:187], v4, s[12:15], s41 offen offset:2048 sc1
s_waitcnt vmcnt(8)
v_mfma_f32_16x16x32_bf16 v[44:47], v[188:191], v[88:91], v[44:47]
v_mfma_f32_16x16x32_bf16 v[40:43], v[188:191], v[84:87], v[40:43]
v_mfma_f32_16x16x32_bf16 v[36:39], v[188:191], v[240:243], v[36:39]
buffer_load_dwordx4 v[188:191], v4, s[12:15], s41 offen offset:3072 sc1
s_waitcnt vmcnt(8)
v_mfma_f32_16x16x32_bf16 v[24:27], v[48:51], v[52:55], v[24:27]
v_mfma_f32_16x16x32_bf16 v[28:31], v[48:51], v[56:59], v[28:31]
v_mfma_f32_16x16x32_bf16 v[32:35], v[48:51], v[60:63], v[32:35]
buffer_load_dwordx4 v[48:51], v4, s[12:15], s42 offen offset:0 sc1
s_setprio 2
ds_read_b128 v[52:55], v5 offset:256
ds_read_b128 v[56:59], v5 offset:288
ds_read_b128 v[60:63], v94 offset:256
ds_read_b128 v[80:83], v1 offset:256
ds_read_b128 v[84:87], v3 offset:256
ds_read_b128 v[88:91], v3 offset:33280
s_waitcnt vmcnt(8)
v_mfma_f32_16x16x32_bf16 v[192:195], v[176:179], v[196:199], 0
v_mfma_f32_16x16x32_bf16 v[208:211], v[176:179], v[68:71], 0
v_mfma_f32_16x16x32_bf16 v[224:227], v[176:179], v[100:103], 0
v_fmac_f32_dpp v24, v36, v92 row_ror:8 row_mask:0xf bank_mask:0xf
v_fmac_f32_dpp v25, v37, v92 row_ror:8 row_mask:0xf bank_mask:0xf
s_add_u32 s40, s40, 9216
s_add_u32 s41, s40, 4096
s_add_u32 s42, s40, 8192
buffer_load_dwordx4 v[176:179], v4, s[12:15], s40 offen offset:0 sc1
s_waitcnt vmcnt(8)
v_mfma_f32_16x16x32_bf16 v[96:99], v[180:183], v[100:103], 0
v_fmac_f32_dpp v26, v38, v92 row_ror:8 row_mask:0xf bank_mask:0xf
v_fmac_f32_dpp v27, v39, v92 row_ror:8 row_mask:0xf bank_mask:0xf
v_mfma_f32_16x16x32_bf16 v[64:67], v[180:183], v[68:71], 0
v_cvt_pk_bf16_f32 v24, v24, v25
v_cvt_pk_bf16_f32 v25, v26, v27
v_mfma_f32_16x16x32_bf16 v[240:243], v[180:183], v[196:199], 0
ds_write_b32 v2, v24 offset:0
ds_write_b32 v2, v25 offset:8
buffer_load_dwordx4 v[180:183], v4, s[12:15], s40 offen offset:1024 sc1
s_waitcnt vmcnt(8)
v_mfma_f32_16x16x32_bf16 v[192:195], v[120:123], v[212:215], v[192:195]
v_fmac_f32_dpp v28, v40, v92 row_ror:8 row_mask:0xf bank_mask:0xf
v_fmac_f32_dpp v29, v41, v92 row_ror:8 row_mask:0xf bank_mask:0xf
v_mfma_f32_16x16x32_bf16 v[208:211], v[120:123], v[164:167], v[208:211]
v_fmac_f32_dpp v30, v42, v92 row_ror:8 row_mask:0xf bank_mask:0xf
v_fmac_f32_dpp v31, v43, v92 row_ror:8 row_mask:0xf bank_mask:0xf
v_mfma_f32_16x16x32_bf16 v[224:227], v[120:123], v[140:143], v[224:227]
v_cvt_pk_bf16_f32 v28, v28, v29
v_cvt_pk_bf16_f32 v29, v30, v31
buffer_load_dwordx4 v[120:123], v4, s[12:15], s40 offen offset:2048 sc1
s_waitcnt vmcnt(8)
v_mfma_f32_16x16x32_bf16 v[96:99], v[124:127], v[140:143], v[96:99]
ds_write_b32 v2, v28 offset:32
ds_write_b32 v2, v29 offset:40
v_mfma_f32_16x16x32_bf16 v[64:67], v[124:127], v[164:167], v[64:67]
v_fmac_f32_dpp v32, v44, v92 row_ror:8 row_mask:0xf bank_mask:0xf
v_fmac_f32_dpp v33, v45, v92 row_ror:8 row_mask:0xf bank_mask:0xf
v_mfma_f32_16x16x32_bf16 v[240:243], v[124:127], v[212:215], v[240:243]
v_fmac_f32_dpp v34, v46, v92 row_ror:8 row_mask:0xf bank_mask:0xf
v_fmac_f32_dpp v35, v47, v92 row_ror:8 row_mask:0xf bank_mask:0xf
buffer_load_dwordx4 v[124:127], v4, s[12:15], s40 offen offset:3072 sc1
s_waitcnt vmcnt(8)
v_mfma_f32_16x16x32_bf16 v[192:195], v[152:155], v[228:231], v[192:195]
v_cvt_pk_bf16_f32 v32, v32, v33
v_cvt_pk_bf16_f32 v33, v34, v35
v_mfma_f32_16x16x32_bf16 v[208:211], v[152:155], v[116:119], v[208:211]
ds_write_b32 v7, v32 offset:0
ds_write_b32 v7, v33 offset:8
s_waitcnt lgkmcnt(8)
v_mfma_f32_16x16x32_bf16 v[224:227], v[152:155], v[80:83], v[224:227]
v_xor_b32 v52, v93, v52
v_xor_b32 v53, v93, v53
buffer_load_dwordx4 v[152:155], v4, s[12:15], s41 offen offset:0 sc1
s_waitcnt vmcnt(8)
v_mfma_f32_16x16x32_bf16 v[96:99], v[156:159], v[80:83], v[96:99]
v_xor_b32 v54, v93, v54
v_xor_b32 v55, v93, v55
v_mfma_f32_16x16x32_bf16 v[64:67], v[156:159], v[116:119], v[64:67]
v_xor_b32 v56, v93, v56
v_xor_b32 v57, v93, v57
v_mfma_f32_16x16x32_bf16 v[240:243], v[156:159], v[228:231], v[240:243]
v_xor_b32 v58, v93, v58
v_xor_b32 v59, v93, v59
buffer_load_dwordx4 v[156:159], v4, s[12:15], s41 offen offset:1024 sc1
s_waitcnt vmcnt(8)
v_mfma_f32_16x16x32_bf16 v[192:195], v[184:187], v[244:247], v[192:195]
v_xor_b32 v60, v93, v60
v_xor_b32 v61, v93, v61
s_waitcnt lgkmcnt(7)
v_mfma_f32_16x16x32_bf16 v[208:211], v[184:187], v[84:87], v[208:211]
v_xor_b32 v62, v93, v62
v_xor_b32 v63, v93, v63
s_waitcnt lgkmcnt(6)
v_mfma_f32_16x16x32_bf16 v[224:227], v[184:187], v[88:91], v[224:227]
buffer_load_dwordx4 v[184:187], v4, s[12:15], s41 offen offset:2048 sc1
s_waitcnt vmcnt(8)
v_mfma_f32_16x16x32_bf16 v[96:99], v[188:191], v[88:91], v[96:99]
v_mfma_f32_16x16x32_bf16 v[64:67], v[188:191], v[84:87], v[64:67]
v_mfma_f32_16x16x32_bf16 v[240:243], v[188:191], v[244:247], v[240:243]
buffer_load_dwordx4 v[188:191], v4, s[12:15], s41 offen offset:3072 sc1
s_waitcnt vmcnt(8)
v_mfma_f32_16x16x32_bf16 v[192:195], v[48:51], v[52:55], v[192:195]
v_mfma_f32_16x16x32_bf16 v[208:211], v[48:51], v[56:59], v[208:211]
v_mfma_f32_16x16x32_bf16 v[224:227], v[48:51], v[60:63], v[224:227]
buffer_load_dwordx4 v[48:51], v4, s[12:15], s42 offen offset:0 sc1
s_waitcnt vmcnt(8)
v_mfma_f32_16x16x32_bf16 v[24:27], v[176:179], v[196:199], 0
v_mfma_f32_16x16x32_bf16 v[28:31], v[176:179], v[68:71], 0
v_mfma_f32_16x16x32_bf16 v[32:35], v[176:179], v[100:103], 0
s_nop 0
v_fmac_f32_dpp v192, v240, v92 row_ror:8 row_mask:0xf bank_mask:0xf
v_fmac_f32_dpp v193, v241, v92 row_ror:8 row_mask:0xf bank_mask:0xf
s_add_u32 s40, s40, 9216
s_add_u32 s41, s40, 4096
s_add_u32 s42, s40, 8192
buffer_load_dwordx4 v[176:179], v4, s[12:15], s40 offen offset:0 sc1
s_waitcnt vmcnt(8)
v_mfma_f32_16x16x32_bf16 v[44:47], v[180:183], v[100:103], 0
v_fmac_f32_dpp v194, v242, v92 row_ror:8 row_mask:0xf bank_mask:0xf
v_fmac_f32_dpp v195, v243, v92 row_ror:8 row_mask:0xf bank_mask:0xf
v_mfma_f32_16x16x32_bf16 v[40:43], v[180:183], v[68:71], 0
v_cvt_pk_bf16_f32 v192, v192, v193
v_cvt_pk_bf16_f32 v193, v194, v195
v_mfma_f32_16x16x32_bf16 v[36:39], v[180:183], v[196:199], 0
ds_write_b32 v6, v192 offset:256
ds_write_b32 v6, v193 offset:264
buffer_load_dwordx4 v[180:183], v4, s[12:15], s40 offen offset:1024 sc1
s_waitcnt vmcnt(8)
v_mfma_f32_16x16x32_bf16 v[24:27], v[120:123], v[212:215], v[24:27]
v_fmac_f32_dpp v208, v64, v92 row_ror:8 row_mask:0xf bank_mask:0xf
v_fmac_f32_dpp v209, v65, v92 row_ror:8 row_mask:0xf bank_mask:0xf
v_mfma_f32_16x16x32_bf16 v[28:31], v[120:123], v[164:167], v[28:31]
v_fmac_f32_dpp v210, v66, v92 row_ror:8 row_mask:0xf bank_mask:0xf
v_fmac_f32_dpp v211, v67, v92 row_ror:8 row_mask:0xf bank_mask:0xf
v_mfma_f32_16x16x32_bf16 v[32:35], v[120:123], v[140:143], v[32:35]
v_cvt_pk_bf16_f32 v208, v208, v209
v_cvt_pk_bf16_f32 v209, v210, v211
buffer_load_dwordx4 v[120:123], v4, s[12:15], s40 offen offset:2048 sc1
s_waitcnt vmcnt(8)
v_mfma_f32_16x16x32_bf16 v[44:47], v[124:127], v[140:143], v[44:47]
ds_write_b32 v6, v208 offset:288
ds_write_b32 v6, v209 offset:296
v_mfma_f32_16x16x32_bf16 v[40:43], v[124:127], v[164:167], v[40:43]
v_fmac_f32_dpp v224, v96, v92 row_ror:8 row_mask:0xf bank_mask:0xf
v_fmac_f32_dpp v225, v97, v92 row_ror:8 row_mask:0xf bank_mask:0xf
v_mfma_f32_16x16x32_bf16 v[36:39], v[124:127], v[212:215], v[36:39]
v_fmac_f32_dpp v226, v98, v92 row_ror:8 row_mask:0xf bank_mask:0xf
v_fmac_f32_dpp v227, v99, v92 row_ror:8 row_mask:0xf bank_mask:0xf
buffer_load_dwordx4 v[124:127], v4, s[12:15], s40 offen offset:3072 sc1
s_waitcnt vmcnt(8)
v_mfma_f32_16x16x32_bf16 v[24:27], v[152:155], v[228:231], v[24:27]
v_cvt_pk_bf16_f32 v224, v224, v225
v_cvt_pk_bf16_f32 v225, v226, v227
v_mfma_f32_16x16x32_bf16 v[28:31], v[152:155], v[116:119], v[28:31]
ds_write_b32 v2, v224 offset:33280
ds_write_b32 v2, v225 offset:33288
v_mfma_f32_16x16x32_bf16 v[32:35], v[152:155], v[80:83], v[32:35]
buffer_load_dwordx4 v[152:155], v4, s[12:15], s41 offen offset:0 sc1
s_waitcnt vmcnt(8)
v_mfma_f32_16x16x32_bf16 v[44:47], v[156:159], v[80:83], v[44:47]
v_mfma_f32_16x16x32_bf16 v[40:43], v[156:159], v[116:119], v[40:43]
v_mfma_f32_16x16x32_bf16 v[36:39], v[156:159], v[228:231], v[36:39]
buffer_load_dwordx4 v[156:159], v4, s[12:15], s41 offen offset:1024 sc1
s_waitcnt vmcnt(8)
v_mfma_f32_16x16x32_bf16 v[24:27], v[184:187], v[244:247], v[24:27]
v_mfma_f32_16x16x32_bf16 v[28:31], v[184:187], v[84:87], v[28:31]
v_mfma_f32_16x16x32_bf16 v[32:35], v[184:187], v[88:91], v[32:35]
buffer_load_dwordx4 v[184:187], v4, s[12:15], s41 offen offset:2048 sc1
s_waitcnt vmcnt(8)
v_mfma_f32_16x16x32_bf16 v[44:47], v[188:191], v[88:91], v[44:47]
v_mfma_f32_16x16x32_bf16 v[40:43], v[188:191], v[84:87], v[40:43]
v_mfma_f32_16x16x32_bf16 v[36:39], v[188:191], v[244:247], v[36:39]
buffer_load_dwordx4 v[188:191], v4, s[12:15], s41 offen offset:3072 sc1
s_waitcnt vmcnt(8)
v_mfma_f32_16x16x32_bf16 v[24:27], v[48:51], v[52:55], v[24:27]
v_mfma_f32_16x16x32_bf16 v[28:31], v[48:51], v[56:59], v[28:31]
v_mfma_f32_16x16x32_bf16 v[32:35], v[48:51], v[60:63], v[32:35]
buffer_load_dwordx4 v[48:51], v4, s[12:15], s42 offen offset:0 sc1
s_waitcnt vmcnt(8)
v_mfma_f32_16x16x32_bf16 v[192:195], v[176:179], v[196:199], 0
v_mfma_f32_16x16x32_bf16 v[208:211], v[176:179], v[68:71], 0
v_mfma_f32_16x16x32_bf16 v[224:227], v[176:179], v[100:103], 0
s_nop 0
v_fmac_f32_dpp v24, v36, v92 row_ror:8 row_mask:0xf bank_mask:0xf
v_fmac_f32_dpp v25, v37, v92 row_ror:8 row_mask:0xf bank_mask:0xf
s_add_u32 s40, s60, 442368
s_add_u32 s41, s40, 4096
s_add_u32 s42, s40, 8192
buffer_load_dwordx4 v[176:179], v4, s[12:15], s40 offen offset:0 sc1
s_waitcnt vmcnt(8)
v_mfma_f32_16x16x32_bf16 v[96:99], v[180:183], v[100:103], 0
v_fmac_f32_dpp v26, v38, v92 row_ror:8 row_mask:0xf bank_mask:0xf
v_fmac_f32_dpp v27, v39, v92 row_ror:8 row_mask:0xf bank_mask:0xf
v_mfma_f32_16x16x32_bf16 v[64:67], v[180:183], v[68:71], 0
v_cvt_pk_bf16_f32 v24, v24, v25
v_cvt_pk_bf16_f32 v25, v26, v27
v_mfma_f32_16x16x32_bf16 v[240:243], v[180:183], v[196:199], 0
ds_write_b32 v6, v24 offset:33280
ds_write_b32 v6, v25 offset:33288
buffer_load_dwordx4 v[180:183], v4, s[12:15], s40 offen offset:1024 sc1
s_waitcnt vmcnt(8)
v_mfma_f32_16x16x32_bf16 v[192:195], v[120:123], v[212:215], v[192:195]
v_fmac_f32_dpp v28, v40, v92 row_ror:8 row_mask:0xf bank_mask:0xf
v_fmac_f32_dpp v29, v41, v92 row_ror:8 row_mask:0xf bank_mask:0xf
v_mfma_f32_16x16x32_bf16 v[208:211], v[120:123], v[164:167], v[208:211]
v_fmac_f32_dpp v30, v42, v92 row_ror:8 row_mask:0xf bank_mask:0xf
v_fmac_f32_dpp v31, v43, v92 row_ror:8 row_mask:0xf bank_mask:0xf
v_mfma_f32_16x16x32_bf16 v[224:227], v[120:123], v[140:143], v[224:227]
v_cvt_pk_bf16_f32 v28, v28, v29
v_cvt_pk_bf16_f32 v29, v30, v31
buffer_load_dwordx4 v[120:123], v4, s[12:15], s40 offen offset:2048 sc1
s_waitcnt vmcnt(8)
v_mfma_f32_16x16x32_bf16 v[96:99], v[124:127], v[140:143], v[96:99]
ds_write_b32 v6, v28 offset:33312
ds_write_b32 v6, v29 offset:33320
v_mfma_f32_16x16x32_bf16 v[64:67], v[124:127], v[164:167], v[64:67]
v_fmac_f32_dpp v32, v44, v92 row_ror:8 row_mask:0xf bank_mask:0xf
v_fmac_f32_dpp v33, v45, v92 row_ror:8 row_mask:0xf bank_mask:0xf
v_mfma_f32_16x16x32_bf16 v[240:243], v[124:127], v[212:215], v[240:243]
v_fmac_f32_dpp v34, v46, v92 row_ror:8 row_mask:0xf bank_mask:0xf
v_fmac_f32_dpp v35, v47, v92 row_ror:8 row_mask:0xf bank_mask:0xf
buffer_load_dwordx4 v[124:127], v4, s[12:15], s40 offen offset:3072 sc1
s_waitcnt vmcnt(8)
v_mfma_f32_16x16x32_bf16 v[192:195], v[152:155], v[228:231], v[192:195]
v_cvt_pk_bf16_f32 v32, v32, v33
v_cvt_pk_bf16_f32 v33, v34, v35
v_mfma_f32_16x16x32_bf16 v[208:211], v[152:155], v[116:119], v[208:211]
ds_write_b32 v2, v32 offset:33312
ds_write_b32 v2, v33 offset:33320
v_mfma_f32_16x16x32_bf16 v[224:227], v[152:155], v[80:83], v[224:227]
buffer_load_dwordx4 v[152:155], v4, s[12:15], s41 offen offset:0 sc1
s_waitcnt vmcnt(8)
v_mfma_f32_16x16x32_bf16 v[96:99], v[156:159], v[80:83], v[96:99]
v_mfma_f32_16x16x32_bf16 v[64:67], v[156:159], v[116:119], v[64:67]
v_mfma_f32_16x16x32_bf16 v[240:243], v[156:159], v[228:231], v[240:243]
buffer_load_dwordx4 v[156:159], v4, s[12:15], s41 offen offset:1024 sc1
s_waitcnt vmcnt(8)
v_mfma_f32_16x16x32_bf16 v[192:195], v[184:187], v[244:247], v[192:195]
v_mfma_f32_16x16x32_bf16 v[208:211], v[184:187], v[84:87], v[208:211]
v_mfma_f32_16x16x32_bf16 v[224:227], v[184:187], v[88:91], v[224:227]
buffer_load_dwordx4 v[184:187], v4, s[12:15], s41 offen offset:2048 sc1
s_waitcnt vmcnt(8)
v_mfma_f32_16x16x32_bf16 v[96:99], v[188:191], v[88:91], v[96:99]
v_mfma_f32_16x16x32_bf16 v[64:67], v[188:191], v[84:87], v[64:67]
v_mfma_f32_16x16x32_bf16 v[240:243], v[188:191], v[244:247], v[240:243]
buffer_load_dwordx4 v[188:191], v4, s[12:15], s41 offen offset:3072 sc1
s_waitcnt vmcnt(8)
v_mfma_f32_16x16x32_bf16 v[192:195], v[48:51], v[52:55], v[192:195]
v_mfma_f32_16x16x32_bf16 v[208:211], v[48:51], v[56:59], v[208:211]
v_mfma_f32_16x16x32_bf16 v[224:227], v[48:51], v[60:63], v[224:227]
buffer_load_dwordx4 v[48:51], v4, s[12:15], s42 offen offset:0 sc1
s_setprio 1
ds_read_b128 v[52:55], v5 offset:512
ds_read_b128 v[56:59], v5 offset:544
ds_read_b128 v[60:63], v94 offset:512
ds_read_b128 v[80:83], v1 offset:512
ds_read_b128 v[84:87], v3 offset:512
ds_read_b128 v[88:91], v3 offset:33536
s_waitcnt vmcnt(8)
v_mfma_f32_16x16x32_bf16 v[24:27], v[176:179], v[200:203], 0
v_mfma_f32_16x16x32_bf16 v[28:31], v[176:179], v[72:75], 0
v_mfma_f32_16x16x32_bf16 v[32:35], v[176:179], v[128:131], 0
v_fmac_f32_dpp v192, v240, v92 row_ror:8 row_mask:0xf bank_mask:0xf
v_fmac_f32_dpp v193, v241, v92 row_ror:8 row_mask:0xf bank_mask:0xf
s_add_u32 s40, s40, 9216
s_add_u32 s41, s40, 4096
s_add_u32 s42, s40, 8192
buffer_load_dwordx4 v[176:179], v4, s[12:15], s40 offen offset:0 sc1
s_waitcnt vmcnt(8)
v_mfma_f32_16x16x32_bf16 v[44:47], v[180:183], v[128:131], 0
v_fmac_f32_dpp v194, v242, v92 row_ror:8 row_mask:0xf bank_mask:0xf
v_fmac_f32_dpp v195, v243, v92 row_ror:8 row_mask:0xf bank_mask:0xf
v_mfma_f32_16x16x32_bf16 v[40:43], v[180:183], v[72:75], 0
v_cvt_pk_bf16_f32 v192, v192, v193
v_cvt_pk_bf16_f32 v193, v194, v195
v_mfma_f32_16x16x32_bf16 v[36:39], v[180:183], v[200:203], 0
ds_write_b32 v2, v192 offset:256
ds_write_b32 v2, v193 offset:264
buffer_load_dwordx4 v[180:183], v4, s[12:15], s40 offen offset:1024 sc1
s_waitcnt vmcnt(8)
v_mfma_f32_16x16x32_bf16 v[24:27], v[120:123], v[216:219], v[24:27]
v_fmac_f32_dpp v208, v64, v92 row_ror:8 row_mask:0xf bank_mask:0xf
v_fmac_f32_dpp v209, v65, v92 row_ror:8 row_mask:0xf bank_mask:0xf
v_mfma_f32_16x16x32_bf16 v[28:31], v[120:123], v[104:107], v[28:31]
v_fmac_f32_dpp v210, v66, v92 row_ror:8 row_mask:0xf bank_mask:0xf
v_fmac_f32_dpp v211, v67, v92 row_ror:8 row_mask:0xf bank_mask:0xf
v_mfma_f32_16x16x32_bf16 v[32:35], v[120:123], v[168:171], v[32:35]
v_cvt_pk_bf16_f32 v208, v208, v209
v_cvt_pk_bf16_f32 v209, v210, v211
buffer_load_dwordx4 v[120:123], v4, s[12:15], s40 offen offset:2048 sc1
s_waitcnt vmcnt(8)
v_mfma_f32_16x16x32_bf16 v[44:47], v[124:127], v[168:171], v[44:47]
ds_write_b32 v2, v208 offset:288
ds_write_b32 v2, v209 offset:296
v_mfma_f32_16x16x32_bf16 v[40:43], v[124:127], v[104:107], v[40:43]
v_fmac_f32_dpp v224, v96, v92 row_ror:8 row_mask:0xf bank_mask:0xf
v_fmac_f32_dpp v225, v97, v92 row_ror:8 row_mask:0xf bank_mask:0xf
v_mfma_f32_16x16x32_bf16 v[36:39], v[124:127], v[216:219], v[36:39]
v_fmac_f32_dpp v226, v98, v92 row_ror:8 row_mask:0xf bank_mask:0xf
v_fmac_f32_dpp v227, v99, v92 row_ror:8 row_mask:0xf bank_mask:0xf
buffer_load_dwordx4 v[124:127], v4, s[12:15], s40 offen offset:3072 sc1
s_waitcnt vmcnt(8)
v_mfma_f32_16x16x32_bf16 v[24:27], v[152:155], v[232:235], v[24:27]
v_cvt_pk_bf16_f32 v224, v224, v225
v_cvt_pk_bf16_f32 v225, v226, v227
v_mfma_f32_16x16x32_bf16 v[28:31], v[152:155], v[144:147], v[28:31]
ds_write_b32 v7, v224 offset:256
ds_write_b32 v7, v225 offset:264
s_waitcnt lgkmcnt(8)
v_mfma_f32_16x16x32_bf16 v[32:35], v[152:155], v[80:83], v[32:35]
v_xor_b32 v52, v93, v52
v_xor_b32 v53, v93, v53
buffer_load_dwordx4 v[152:155], v4, s[12:15], s41 offen offset:0 sc1
s_waitcnt vmcnt(8)
v_mfma_f32_16x16x32_bf16 v[44:47], v[156:159], v[80:83], v[44:47]
v_xor_b32 v54, v93, v54
v_xor_b32 v55, v93, v55
v_mfma_f32_16x16x32_bf16 v[40:43], v[156:159], v[144:147], v[40:43]
v_xor_b32 v56, v93, v56
v_xor_b32 v57, v93, v57
v_mfma_f32_16x16x32_bf16 v[36:39], v[156:159], v[232:235], v[36:39]
v_xor_b32 v58, v93, v58
v_xor_b32 v59, v93, v59
buffer_load_dwordx4 v[156:159], v4, s[12:15], s41 offen offset:1024 sc1
s_waitcnt vmcnt(8)
v_mfma_f32_16x16x32_bf16 v[24:27], v[184:187], v[248:251], v[24:27]
v_xor_b32 v60, v93, v60
v_xor_b32 v61, v93, v61
s_waitcnt lgkmcnt(7)
v_mfma_f32_16x16x32_bf16 v[28:31], v[184:187], v[84:87], v[28:31]
v_xor_b32 v62, v93, v62
v_xor_b32 v63, v93, v63
s_waitcnt lgkmcnt(6)
v_mfma_f32_16x16x32_bf16 v[32:35], v[184:187], v[88:91], v[32:35]
buffer_load_dwordx4 v[184:187], v4, s[12:15], s41 offen offset:2048 sc1
s_waitcnt vmcnt(8)
v_mfma_f32_16x16x32_bf16 v[44:47], v[188:191], v[88:91], v[44:47]
v_mfma_f32_16x16x32_bf16 v[40:43], v[188:191], v[84:87], v[40:43]
v_mfma_f32_16x16x32_bf16 v[36:39], v[188:191], v[248:251], v[36:39]
buffer_load_dwordx4 v[188:191], v4, s[12:15], s41 offen offset:3072 sc1
s_waitcnt vmcnt(8)
v_mfma_f32_16x16x32_bf16 v[24:27], v[48:51], v[52:55], v[24:27]
v_mfma_f32_16x16x32_bf16 v[28:31], v[48:51], v[56:59], v[28:31]
v_mfma_f32_16x16x32_bf16 v[32:35], v[48:51], v[60:63], v[32:35]
buffer_load_dwordx4 v[48:51], v4, s[12:15], s42 offen offset:0 sc1
s_waitcnt vmcnt(8)
v_mfma_f32_16x16x32_bf16 v[192:195], v[176:179], v[200:203], 0
v_mfma_f32_16x16x32_bf16 v[208:211], v[176:179], v[72:75], 0
v_mfma_f32_16x16x32_bf16 v[224:227], v[176:179], v[128:131], 0
s_nop 0
v_fmac_f32_dpp v24, v36, v92 row_ror:8 row_mask:0xf bank_mask:0xf
v_fmac_f32_dpp v25, v37, v92 row_ror:8 row_mask:0xf bank_mask:0xf
s_add_u32 s40, s40, 9216
s_add_u32 s41, s40, 4096
s_add_u32 s42, s40, 8192
buffer_load_dwordx4 v[176:179], v4, s[12:15], s40 offen offset:0 sc1
s_waitcnt vmcnt(8)
v_mfma_f32_16x16x32_bf16 v[96:99], v[180:183], v[128:131], 0
v_fmac_f32_dpp v26, v38, v92 row_ror:8 row_mask:0xf bank_mask:0xf
v_fmac_f32_dpp v27, v39, v92 row_ror:8 row_mask:0xf bank_mask:0xf
v_mfma_f32_16x16x32_bf16 v[64:67], v[180:183], v[72:75], 0
v_cvt_pk_bf16_f32 v24, v24, v25
v_cvt_pk_bf16_f32 v25, v26, v27
v_mfma_f32_16x16x32_bf16 v[240:243], v[180:183], v[200:203], 0
ds_write_b32 v6, v24 offset:512
ds_write_b32 v6, v25 offset:520
buffer_load_dwordx4 v[180:183], v4, s[12:15], s40 offen offset:1024 sc1
s_waitcnt vmcnt(8)
v_mfma_f32_16x16x32_bf16 v[192:195], v[120:123], v[216:219], v[192:195]
v_fmac_f32_dpp v28, v40, v92 row_ror:8 row_mask:0xf bank_mask:0xf
v_fmac_f32_dpp v29, v41, v92 row_ror:8 row_mask:0xf bank_mask:0xf
v_mfma_f32_16x16x32_bf16 v[208:211], v[120:123], v[104:107], v[208:211]
v_fmac_f32_dpp v30, v42, v92 row_ror:8 row_mask:0xf bank_mask:0xf
v_fmac_f32_dpp v31, v43, v92 row_ror:8 row_mask:0xf bank_mask:0xf
v_mfma_f32_16x16x32_bf16 v[224:227], v[120:123], v[168:171], v[224:227]
v_cvt_pk_bf16_f32 v28, v28, v29
v_cvt_pk_bf16_f32 v29, v30, v31
buffer_load_dwordx4 v[120:123], v4, s[12:15], s40 offen offset:2048 sc1
s_waitcnt vmcnt(8)
v_mfma_f32_16x16x32_bf16 v[96:99], v[124:127], v[168:171], v[96:99]
ds_write_b32 v6, v28 offset:544
ds_write_b32 v6, v29 offset:552
v_mfma_f32_16x16x32_bf16 v[64:67], v[124:127], v[104:107], v[64:67]
v_fmac_f32_dpp v32, v44, v92 row_ror:8 row_mask:0xf bank_mask:0xf
v_fmac_f32_dpp v33, v45, v92 row_ror:8 row_mask:0xf bank_mask:0xf
v_mfma_f32_16x16x32_bf16 v[240:243], v[124:127], v[216:219], v[240:243]
v_fmac_f32_dpp v34, v46, v92 row_ror:8 row_mask:0xf bank_mask:0xf
v_fmac_f32_dpp v35, v47, v92 row_ror:8 row_mask:0xf bank_mask:0xf
buffer_load_dwordx4 v[124:127], v4, s[12:15], s40 offen offset:3072 sc1
s_waitcnt vmcnt(8)
v_mfma_f32_16x16x32_bf16 v[192:195], v[152:155], v[232:235], v[192:195]
v_cvt_pk_bf16_f32 v32, v32, v33
v_cvt_pk_bf16_f32 v33, v34, v35
v_mfma_f32_16x16x32_bf16 v[208:211], v[152:155], v[144:147], v[208:211]
ds_write_b32 v2, v32 offset:33536
ds_write_b32 v2, v33 offset:33544
v_mfma_f32_16x16x32_bf16 v[224:227], v[152:155], v[80:83], v[224:227]
v_bfe_u32 v68, v0, 4, 1
v_mul_u32_u24 v68, 2080, v68
buffer_load_dwordx4 v[152:155], v4, s[12:15], s41 offen offset:0 sc1
s_waitcnt vmcnt(8)
v_mfma_f32_16x16x32_bf16 v[96:99], v[156:159], v[80:83], v[96:99]
v_lshrrev_b32 v69, 5, v0
v_lshl_add_u32 v68, v69, 8, v68
v_mfma_f32_16x16x32_bf16 v[64:67], v[156:159], v[144:147], v[64:67]
v_bfe_u32 v69, v0, 2, 2
v_lshl_add_u32 v68, v69, 6, v68
v_mfma_f32_16x16x32_bf16 v[240:243], v[156:159], v[232:235], v[240:243]
v_and_b32 v69, 3, v0
v_mul_u32_u24 v69, 3, v69
buffer_load_dwordx4 v[156:159], v4, s[12:15], s41 offen offset:1024 sc1
s_waitcnt vmcnt(8)
v_mfma_f32_16x16x32_bf16 v[192:195], v[184:187], v[248:251], v[192:195]
s_lshr_b32 s43, s3, 2
s_add_u32 s37, s62, 99072
v_mfma_f32_16x16x32_bf16 v[208:211], v[184:187], v[84:87], v[208:211]
s_add_u32 s39, s63, 132096
v_mov_b32 v100, s39
v_mfma_f32_16x16x32_bf16 v[224:227], v[184:187], v[88:91], v[224:227]
v_add_u32 v70, 0, v69
v_lshrrev_b32 v71, 2, v70
buffer_load_dwordx4 v[184:187], v4, s[12:15], s41 offen offset:2048 sc1
s_waitcnt vmcnt(8)
v_mfma_f32_16x16x32_bf16 v[96:99], v[188:191], v[88:91], v[96:99]
v_and_b32 v70, 3, v70
v_lshl_add_u32 v70, v70, 3, v68
v_mfma_f32_16x16x32_bf16 v[64:67], v[188:191], v[84:87], v[64:67]
v_mul_u32_u24 v101, 33024, v71
v_add3_u32 v196, v101, v70, s62
v_mfma_f32_16x16x32_bf16 v[240:243], v[188:191], v[248:251], v[240:243]
v_xor_b32 v197, 16, v196
v_cmp_eq_u32 vcc, 2, v71
buffer_load_dwordx4 v[188:191], v4, s[12:15], s41 offen offset:3072 sc1
s_waitcnt vmcnt(8)
v_mfma_f32_16x16x32_bf16 v[192:195], v[48:51], v[52:55], v[192:195]
v_lshl_add_u32 v101, v71, 5, s37
v_cndmask_b32 v101, v101, v100, vcc
v_mfma_f32_16x16x32_bf16 v[208:211], v[48:51], v[56:59], v[208:211]
v_add_u32 v214, v101, v70
v_xor_b32 v215, 16, v214
v_mfma_f32_16x16x32_bf16 v[224:227], v[48:51], v[60:63], v[224:227]
v_add_u32 v70, 1, v69
v_lshrrev_b32 v71, 2, v70
buffer_load_dwordx4 v[48:51], v4, s[12:15], s42 offen offset:0 sc1
v_and_b32 v70, 3, v70
v_lshl_add_u32 v70, v70, 3, v68
v_mul_u32_u24 v101, 33024, v71
v_add3_u32 v198, v101, v70, s62
v_xor_b32 v199, 16, v198
v_cmp_eq_u32 vcc, 2, v71
v_lshl_add_u32 v101, v71, 5, s37
s_nop 0
v_cndmask_b32 v101, v101, v100, vcc
v_add_u32 v228, v101, v70
s_waitcnt vmcnt(8)
v_mfma_f32_16x16x32_bf16 v[24:27], v[176:179], v[200:203], 0
v_mfma_f32_16x16x32_bf16 v[28:31], v[176:179], v[72:75], 0
v_mfma_f32_16x16x32_bf16 v[32:35], v[176:179], v[128:131], 0
v_fmac_f32_dpp v192, v240, v92 row_ror:8 row_mask:0xf bank_mask:0xf
v_fmac_f32_dpp v193, v241, v92 row_ror:8 row_mask:0xf bank_mask:0xf
s_add_u32 s40, s60, 552960
s_add_u32 s41, s40, 4096
s_add_u32 s42, s40, 8192
buffer_load_dwordx4 v[176:179], v4, s[12:15], s40 offen offset:0 sc1
s_waitcnt vmcnt(8)
v_mfma_f32_16x16x32_bf16 v[44:47], v[180:183], v[128:131], 0
v_fmac_f32_dpp v194, v242, v92 row_ror:8 row_mask:0xf bank_mask:0xf
v_fmac_f32_dpp v195, v243, v92 row_ror:8 row_mask:0xf bank_mask:0xf
v_mfma_f32_16x16x32_bf16 v[40:43], v[180:183], v[72:75], 0
v_cvt_pk_bf16_f32 v192, v192, v193
v_cvt_pk_bf16_f32 v193, v194, v195
v_mfma_f32_16x16x32_bf16 v[36:39], v[180:183], v[200:203], 0
ds_write_b32 v6, v192 offset:33536
ds_write_b32 v6, v193 offset:33544
buffer_load_dwordx4 v[180:183], v4, s[12:15], s40 offen offset:1024 sc1
s_waitcnt vmcnt(8)
v_mfma_f32_16x16x32_bf16 v[24:27], v[120:123], v[216:219], v[24:27]
v_fmac_f32_dpp v208, v64, v92 row_ror:8 row_mask:0xf bank_mask:0xf
v_fmac_f32_dpp v209, v65, v92 row_ror:8 row_mask:0xf bank_mask:0xf
v_mfma_f32_16x16x32_bf16 v[28:31], v[120:123], v[104:107], v[28:31]
v_fmac_f32_dpp v210, v66, v92 row_ror:8 row_mask:0xf bank_mask:0xf
v_fmac_f32_dpp v211, v67, v92 row_ror:8 row_mask:0xf bank_mask:0xf
v_mfma_f32_16x16x32_bf16 v[32:35], v[120:123], v[168:171], v[32:35]
v_cvt_pk_bf16_f32 v208, v208, v209
v_cvt_pk_bf16_f32 v209, v210, v211
buffer_load_dwordx4 v[120:123], v4, s[12:15], s40 offen offset:2048 sc1
s_waitcnt vmcnt(8)
v_mfma_f32_16x16x32_bf16 v[44:47], v[124:127], v[168:171], v[44:47]
ds_write_b32 v6, v208 offset:33568
ds_write_b32 v6, v209 offset:33576
v_mfma_f32_16x16x32_bf16 v[40:43], v[124:127], v[104:107], v[40:43]
v_fmac_f32_dpp v224, v96, v92 row_ror:8 row_mask:0xf bank_mask:0xf
v_fmac_f32_dpp v225, v97, v92 row_ror:8 row_mask:0xf bank_mask:0xf
v_mfma_f32_16x16x32_bf16 v[36:39], v[124:127], v[216:219], v[36:39]
v_fmac_f32_dpp v226, v98, v92 row_ror:8 row_mask:0xf bank_mask:0xf
v_fmac_f32_dpp v227, v99, v92 row_ror:8 row_mask:0xf bank_mask:0xf
buffer_load_dwordx4 v[124:127], v4, s[12:15], s40 offen offset:3072 sc1
s_waitcnt vmcnt(8)
v_mfma_f32_16x16x32_bf16 v[24:27], v[152:155], v[232:235], v[24:27]
v_cvt_pk_bf16_f32 v224, v224, v225
v_cvt_pk_bf16_f32 v225, v226, v227
v_mfma_f32_16x16x32_bf16 v[28:31], v[152:155], v[144:147], v[28:31]
ds_write_b32 v2, v224 offset:33568
ds_write_b32 v2, v225 offset:33576
v_mfma_f32_16x16x32_bf16 v[32:35], v[152:155], v[80:83], v[32:35]
v_xor_b32 v229, 16, v228
v_add_u32 v70, 2, v69
buffer_load_dwordx4 v[152:155], v4, s[12:15], s41 offen offset:0 sc1
s_waitcnt vmcnt(8)
v_mfma_f32_16x16x32_bf16 v[44:47], v[156:159], v[80:83], v[44:47]
v_lshrrev_b32 v71, 2, v70
v_and_b32 v70, 3, v70
v_mfma_f32_16x16x32_bf16 v[40:43], v[156:159], v[144:147], v[40:43]
v_lshl_add_u32 v70, v70, 3, v68
v_mul_u32_u24 v101, 33024, v71
v_mfma_f32_16x16x32_bf16 v[36:39], v[156:159], v[232:235], v[36:39]
v_add3_u32 v212, v101, v70, s62
v_xor_b32 v213, 16, v212
buffer_load_dwordx4 v[156:159], v4, s[12:15], s41 offen offset:1024 sc1
s_waitcnt vmcnt(8)
v_mfma_f32_16x16x32_bf16 v[24:27], v[184:187], v[248:251], v[24:27]
v_cmp_eq_u32 vcc, 2, v71
v_lshl_add_u32 v101, v71, 5, s37
v_mfma_f32_16x16x32_bf16 v[28:31], v[184:187], v[84:87], v[28:31]
v_cndmask_b32 v101, v101, v100, vcc
v_add_u32 v230, v101, v70
v_mfma_f32_16x16x32_bf16 v[32:35], v[184:187], v[88:91], v[32:35]
v_xor_b32 v231, 16, v230
s_mul_i32 s37, s52, 48
buffer_load_dwordx4 v[184:187], v4, s[12:15], s41 offen offset:2048 sc1
s_waitcnt vmcnt(8)
v_mfma_f32_16x16x32_bf16 v[44:47], v[188:191], v[88:91], v[44:47]
s_add_u32 s37, s37, s56
v_and_b32 v71, 3, v0
v_mfma_f32_16x16x32_bf16 v[40:43], v[188:191], v[84:87], v[40:43]
v_mul_u32_u24 v69, 12, v71
v_lshrrev_b32 v70, 2, v0
v_mfma_f32_16x16x32_bf16 v[36:39], v[188:191], v[248:251], v[36:39]
v_and_b32 v68, 12, v0
v_lshl_add_u32 v68, v71, 4, v68
buffer_load_dwordx4 v[188:191], v4, s[12:15], s41 offen offset:3072 sc1
s_waitcnt vmcnt(8)
v_mfma_f32_16x16x32_bf16 v[24:27], v[48:51], v[52:55], v[24:27]
v_bfe_u32 v71, v0, 4, 1
v_lshl_add_u32 v68, v71, 1, v68
v_mfma_f32_16x16x32_bf16 v[28:31], v[48:51], v[56:59], v[28:31]
v_lshrrev_b32 v71, 5, v0
v_add_lshl_u32 v246, v71, v68, 2
v_mfma_f32_16x16x32_bf16 v[32:35], v[48:51], v[60:63], v[32:35]
v_mul_u32_u24 v70, 576, v70
v_add3_u32 v244, v69, v70, s37
buffer_load_dwordx4 v[48:51], v4, s[12:15], s42 offen offset:0 sc1
v_add_u32 v245, 9216, v244
v_swap_b32 v10, v16
v_swap_b32 v11, v17
v_swap_b32 v14, v20
v_swap_b32 v15, v21
s_mov_b32 s44, 729808896
s_mov_b32 s46, 738197504
s_mov_b32 s45, 729808896
s_mov_b32 s47, 738197504
s_waitcnt lgkmcnt(0)
s_barrier
s_setprio 0
ds_read_b128 v[52:55], v5 offset:768
ds_read_b128 v[56:59], v5 offset:800
ds_read_b128 v[60:63], v94 offset:768
ds_read_b128 v[80:83], v1 offset:768
ds_read_b128 v[84:87], v3 offset:768
ds_read_b128 v[88:91], v3 offset:33792
s_waitcnt vmcnt(8)
v_mfma_f32_16x16x32_bf16 v[192:195], v[176:179], v[204:207], 0
v_mfma_f32_16x16x32_bf16 v[208:211], v[176:179], v[76:79], 0
v_mfma_f32_16x16x32_bf16 v[224:227], v[176:179], v[132:135], 0
v_fmac_f32_dpp v24, v36, v92 row_ror:8 row_mask:0xf bank_mask:0xf
v_fmac_f32_dpp v25, v37, v92 row_ror:8 row_mask:0xf bank_mask:0xf
s_add_u32 s40, s40, 9216
s_add_u32 s41, s40, 4096
s_add_u32 s42, s40, 8192
buffer_load_dwordx4 v[176:179], v4, s[12:15], s40 offen offset:0 sc1
s_waitcnt vmcnt(8)
v_mfma_f32_16x16x32_bf16 v[96:99], v[180:183], v[132:135], 0
v_fmac_f32_dpp v26, v38, v92 row_ror:8 row_mask:0xf bank_mask:0xf
v_fmac_f32_dpp v27, v39, v92 row_ror:8 row_mask:0xf bank_mask:0xf
ds_read_b64_tr_b16 v[68:69], v196 offset:0
ds_read_b64_tr_b16 v[70:71], v197 offset:1024
v_mfma_f32_16x16x32_bf16 v[64:67], v[180:183], v[76:79], 0
v_cvt_pk_bf16_f32 v24, v24, v25
v_cvt_pk_bf16_f32 v25, v26, v27
v_mfma_f32_16x16x32_bf16 v[240:243], v[180:183], v[204:207], 0
ds_write_b32 v2, v24 offset:512
ds_write_b32 v2, v25 offset:520
buffer_load_dwordx4 v[180:183], v4, s[12:15], s40 offen offset:1024 sc1
s_waitcnt vmcnt(8)
v_mfma_f32_16x16x32_bf16 v[192:195], v[120:123], v[220:223], v[192:195]
v_fmac_f32_dpp v28, v40, v92 row_ror:8 row_mask:0xf bank_mask:0xf
v_fmac_f32_dpp v29, v41, v92 row_ror:8 row_mask:0xf bank_mask:0xf
v_mfma_f32_16x16x32_bf16 v[208:211], v[120:123], v[108:111], v[208:211]
v_fmac_f32_dpp v30, v42, v92 row_ror:8 row_mask:0xf bank_mask:0xf
v_fmac_f32_dpp v31, v43, v92 row_ror:8 row_mask:0xf bank_mask:0xf
v_mfma_f32_16x16x32_bf16 v[224:227], v[120:123], v[172:175], v[224:227]
v_cvt_pk_bf16_f32 v28, v28, v29
v_cvt_pk_bf16_f32 v29, v30, v31
buffer_load_dwordx4 v[120:123], v4, s[12:15], s40 offen offset:2048 sc1
s_waitcnt vmcnt(8)
v_mfma_f32_16x16x32_bf16 v[96:99], v[124:127], v[172:175], v[96:99]
ds_write_b32 v2, v28 offset:544
ds_write_b32 v2, v29 offset:552
v_mfma_f32_16x16x32_bf16 v[64:67], v[124:127], v[108:111], v[64:67]
v_fmac_f32_dpp v32, v44, v92 row_ror:8 row_mask:0xf bank_mask:0xf
v_fmac_f32_dpp v33, v45, v92 row_ror:8 row_mask:0xf bank_mask:0xf
ds_read_b64_tr_b16 v[100:101], v198 offset:0
ds_read_b64_tr_b16 v[102:103], v199 offset:1024
v_mfma_f32_16x16x32_bf16 v[240:243], v[124:127], v[220:223], v[240:243]
v_fmac_f32_dpp v34, v46, v92 row_ror:8 row_mask:0xf bank_mask:0xf
v_fmac_f32_dpp v35, v47, v92 row_ror:8 row_mask:0xf bank_mask:0xf
buffer_load_dwordx4 v[124:127], v4, s[12:15], s40 offen offset:3072 sc1
s_waitcnt vmcnt(8)
v_mfma_f32_16x16x32_bf16 v[192:195], v[152:155], v[236:239], v[192:195]
v_cvt_pk_bf16_f32 v32, v32, v33
v_cvt_pk_bf16_f32 v33, v34, v35
s_waitcnt lgkmcnt(6)
v_mfma_f32_16x16x32_bf16 v[200:203], v[68:71], v[8:11], 0
v_mfma_f32_16x16x32_bf16 v[208:211], v[152:155], v[148:151], v[208:211]
ds_write_b32 v7, v32 offset:512
ds_write_b32 v7, v33 offset:520
v_mfma_f32_16x16x32_bf16 v[224:227], v[152:155], v[80:83], v[224:227]
v_xor_b32 v52, v93, v52
v_xor_b32 v53, v93, v53
buffer_load_dwordx4 v[152:155], v4, s[12:15], s41 offen offset:0 sc1
s_waitcnt vmcnt(8)
v_mfma_f32_16x16x32_bf16 v[96:99], v[156:159], v[80:83], v[96:99]
v_xor_b32 v54, v93, v54
v_xor_b32 v55, v93, v55
v_mfma_f32_16x16x32_bf16 v[248:251], v[68:71], v[12:15], 0
v_mfma_f32_16x16x32_bf16 v[64:67], v[156:159], v[148:151], v[64:67]
v_xor_b32 v56, v93, v56
v_xor_b32 v57, v93, v57
v_mfma_f32_16x16x32_bf16 v[240:243], v[156:159], v[236:239], v[240:243]
v_xor_b32 v58, v93, v58
v_xor_b32 v59, v93, v59
ds_read_b64_tr_b16 v[164:165], v212 offset:0
ds_read_b64_tr_b16 v[166:167], v213 offset:1024
buffer_load_dwordx4 v[156:159], v4, s[12:15], s41 offen offset:1024 sc1
s_waitcnt vmcnt(8)
v_mfma_f32_16x16x32_bf16 v[192:195], v[184:187], v[252:255], v[192:195]
v_xor_b32 v60, v93, v60
v_xor_b32 v61, v93, v61
v_mfma_f32_16x16x32_bf16 v[208:211], v[184:187], v[84:87], v[208:211]
v_xor_b32 v62, v93, v62
v_xor_b32 v63, v93, v63
s_waitcnt lgkmcnt(4)
v_mfma_f32_16x16x32_bf16 v[216:219], v[100:103], v[8:11], 0
v_mfma_f32_16x16x32_bf16 v[224:227], v[184:187], v[88:91], v[224:227]
buffer_load_dwordx4 v[184:187], v4, s[12:15], s41 offen offset:2048 sc1
s_waitcnt vmcnt(8)
v_mfma_f32_16x16x32_bf16 v[96:99], v[188:191], v[88:91], v[96:99]
v_mfma_f32_16x16x32_bf16 v[64:67], v[188:191], v[84:87], v[64:67]
v_mfma_f32_16x16x32_bf16 v[72:75], v[100:103], v[12:15], 0
v_mfma_f32_16x16x32_bf16 v[240:243], v[188:191], v[252:255], v[240:243]
buffer_load_dwordx4 v[188:191], v4, s[12:15], s41 offen offset:3072 sc1
s_waitcnt vmcnt(8)
v_mfma_f32_16x16x32_bf16 v[192:195], v[48:51], v[52:55], v[192:195]
ds_read_b64_tr_b16 v[140:141], v196 offset:32
ds_read_b64_tr_b16 v[142:143], v197 offset:1056
v_mfma_f32_16x16x32_bf16 v[208:211], v[48:51], v[56:59], v[208:211]
v_mfma_f32_16x16x32_bf16 v[224:227], v[48:51], v[60:63], v[224:227]
s_waitcnt lgkmcnt(2)
v_mfma_f32_16x16x32_bf16 v[232:235], v[164:167], v[8:11], 0
buffer_load_dwordx4 v[48:51], v4, s[12:15], s42 offen offset:0 sc1
s_waitcnt vmcnt(8)
v_mfma_f32_16x16x32_bf16 v[24:27], v[176:179], v[204:207], 0
v_mfma_f32_16x16x32_bf16 v[28:31], v[176:179], v[76:79], 0
v_mfma_f32_16x16x32_bf16 v[32:35], v[176:179], v[132:135], 0
v_fmac_f32_dpp v192, v240, v92 row_ror:8 row_mask:0xf bank_mask:0xf
v_fmac_f32_dpp v193, v241, v92 row_ror:8 row_mask:0xf bank_mask:0xf
v_mfma_f32_16x16x32_bf16 v[128:131], v[164:167], v[12:15], 0
s_add_u32 s40, s40, 9216
s_add_u32 s41, s40, 4096
s_add_u32 s42, s40, 8192
buffer_load_dwordx4 v[176:179], v4, s[12:15], s40 offen offset:0 sc1
s_waitcnt vmcnt(8)
v_mfma_f32_16x16x32_bf16 v[44:47], v[180:183], v[132:135], 0
v_fmac_f32_dpp v194, v242, v92 row_ror:8 row_mask:0xf bank_mask:0xf
v_fmac_f32_dpp v195, v243, v92 row_ror:8 row_mask:0xf bank_mask:0xf
v_mfma_f32_16x16x32_bf16 v[40:43], v[180:183], v[76:79], 0
v_cvt_pk_bf16_f32 v192, v192, v193
v_cvt_pk_bf16_f32 v193, v194, v195
ds_read_b64_tr_b16 v[116:117], v198 offset:32
ds_read_b64_tr_b16 v[118:119], v199 offset:1056
v_mfma_f32_16x16x32_bf16 v[36:39], v[180:183], v[204:207], 0
ds_write_b32 v6, v192 offset:768
ds_write_b32 v6, v193 offset:776
buffer_load_dwordx4 v[180:183], v4, s[12:15], s40 offen offset:1024 sc1
s_waitcnt vmcnt(8)
v_mfma_f32_16x16x32_bf16 v[24:27], v[120:123], v[220:223], v[24:27]
v_fmac_f32_dpp v208, v64, v92 row_ror:8 row_mask:0xf bank_mask:0xf
v_fmac_f32_dpp v209, v65, v92 row_ror:8 row_mask:0xf bank_mask:0xf
s_waitcnt lgkmcnt(4)
v_mfma_f32_16x16x32_bf16 v[104:107], v[140:143], v[8:11], 0
v_mfma_f32_16x16x32_bf16 v[28:31], v[120:123], v[108:111], v[28:31]
v_fmac_f32_dpp v210, v66, v92 row_ror:8 row_mask:0xf bank_mask:0xf
v_fmac_f32_dpp v211, v67, v92 row_ror:8 row_mask:0xf bank_mask:0xf
v_mfma_f32_16x16x32_bf16 v[32:35], v[120:123], v[172:175], v[32:35]
v_cvt_pk_bf16_f32 v208, v208, v209
v_cvt_pk_bf16_f32 v209, v210, v211
buffer_load_dwordx4 v[120:123], v4, s[12:15], s40 offen offset:2048 sc1
s_waitcnt vmcnt(8)
v_mfma_f32_16x16x32_bf16 v[44:47], v[124:127], v[172:175], v[44:47]
ds_write_b32 v6, v208 offset:800
ds_write_b32 v6, v209 offset:808
v_mfma_f32_16x16x32_bf16 v[160:163], v[140:143], v[12:15], 0
v_mfma_f32_16x16x32_bf16 v[40:43], v[124:127], v[108:111], v[40:43]
v_fmac_f32_dpp v224, v96, v92 row_ror:8 row_mask:0xf bank_mask:0xf
v_fmac_f32_dpp v225, v97, v92 row_ror:8 row_mask:0xf bank_mask:0xf
v_mfma_f32_16x16x32_bf16 v[36:39], v[124:127], v[220:223], v[36:39]
v_fmac_f32_dpp v226, v98, v92 row_ror:8 row_mask:0xf bank_mask:0xf
v_fmac_f32_dpp v227, v99, v92 row_ror:8 row_mask:0xf bank_mask:0xf
ds_read_b64_tr_b16 v[68:69], v212 offset:32
ds_read_b64_tr_b16 v[70:71], v213 offset:1056
buffer_load_dwordx4 v[124:127], v4, s[12:15], s40 offen offset:3072 sc1
s_waitcnt vmcnt(8)
v_mfma_f32_16x16x32_bf16 v[24:27], v[152:155], v[236:239], v[24:27]
v_cvt_pk_bf16_f32 v224, v224, v225
v_cvt_pk_bf16_f32 v225, v226, v227
v_mfma_f32_16x16x32_bf16 v[28:31], v[152:155], v[148:151], v[28:31]
ds_write_b32 v2, v224 offset:33792
ds_write_b32 v2, v225 offset:33800
s_waitcnt lgkmcnt(8)
v_mfma_f32_16x16x32_bf16 v[168:171], v[116:119], v[8:11], 0
v_mfma_f32_16x16x32_bf16 v[32:35], v[152:155], v[80:83], v[32:35]
buffer_load_dwordx4 v[152:155], v4, s[12:15], s41 offen offset:0 sc1
s_waitcnt vmcnt(8)
v_mfma_f32_16x16x32_bf16 v[44:47], v[156:159], v[80:83], v[44:47]
v_mfma_f32_16x16x32_bf16 v[40:43], v[156:159], v[148:151], v[40:43]
v_mfma_f32_16x16x32_bf16 v[136:139], v[116:119], v[12:15], 0
v_mfma_f32_16x16x32_bf16 v[36:39], v[156:159], v[236:239], v[36:39]
buffer_load_dwordx4 v[156:159], v4, s[12:15], s41 offen offset:1024 sc1
s_waitcnt vmcnt(8)
v_mfma_f32_16x16x32_bf16 v[24:27], v[184:187], v[252:255], v[24:27]
v_mfma_f32_16x16x32_bf16 v[28:31], v[184:187], v[84:87], v[28:31]
v_mfma_f32_16x16x32_bf16 v[32:35], v[184:187], v[88:91], v[32:35]
s_waitcnt lgkmcnt(2)
v_mfma_f32_16x16x32_bf16 v[144:147], v[68:71], v[8:11], 0
buffer_load_dwordx4 v[184:187], v4, s[12:15], s41 offen offset:2048 sc1
s_waitcnt vmcnt(8)
v_mfma_f32_16x16x32_bf16 v[44:47], v[188:191], v[88:91], v[44:47]
v_mfma_f32_16x16x32_bf16 v[40:43], v[188:191], v[84:87], v[40:43]
v_mfma_f32_16x16x32_bf16 v[36:39], v[188:191], v[252:255], v[36:39]
v_mfma_f32_16x16x32_bf16 v[112:115], v[68:71], v[12:15], 0
buffer_load_dwordx4 v[188:191], v4, s[12:15], s41 offen offset:3072 sc1
s_waitcnt vmcnt(8)
v_mfma_f32_16x16x32_bf16 v[24:27], v[48:51], v[52:55], v[24:27]
v_mfma_f32_16x16x32_bf16 v[28:31], v[48:51], v[56:59], v[28:31]
v_mfma_f32_16x16x32_bf16 v[32:35], v[48:51], v[60:63], v[32:35]
buffer_load_dwordx4 v[48:51], v4, s[12:15], s42 offen offset:0 sc1
s_waitcnt vmcnt(8)
v_mfma_f32_16x16x32_bf16 v[192:195], v[176:179], v[204:207], 0
v_mfma_f32_16x16x32_bf16 v[208:211], v[176:179], v[76:79], 0
v_mfma_f32_16x16x32_bf16 v[224:227], v[176:179], v[132:135], 0
s_nop 0
v_fmac_f32_dpp v24, v36, v92 row_ror:8 row_mask:0xf bank_mask:0xf
v_fmac_f32_dpp v25, v37, v92 row_ror:8 row_mask:0xf bank_mask:0xf
s_waitcnt vmcnt(7)
v_mfma_f32_16x16x32_bf16 v[96:99], v[180:183], v[132:135], 0
v_fmac_f32_dpp v26, v38, v92 row_ror:8 row_mask:0xf bank_mask:0xf
v_fmac_f32_dpp v27, v39, v92 row_ror:8 row_mask:0xf bank_mask:0xf
v_mfma_f32_16x16x32_bf16 v[64:67], v[180:183], v[76:79], 0
v_cvt_pk_bf16_f32 v24, v24, v25
v_cvt_pk_bf16_f32 v25, v26, v27
v_mfma_f32_16x16x32_bf16 v[240:243], v[180:183], v[204:207], 0
ds_write_b32 v6, v24 offset:33792
ds_write_b32 v6, v25 offset:33800
s_waitcnt vmcnt(6)
v_mfma_f32_16x16x32_bf16 v[192:195], v[120:123], v[220:223], v[192:195]
v_fmac_f32_dpp v28, v40, v92 row_ror:8 row_mask:0xf bank_mask:0xf
v_fmac_f32_dpp v29, v41, v92 row_ror:8 row_mask:0xf bank_mask:0xf
v_mfma_f32_16x16x32_bf16 v[208:211], v[120:123], v[108:111], v[208:211]
v_fmac_f32_dpp v30, v42, v92 row_ror:8 row_mask:0xf bank_mask:0xf
v_fmac_f32_dpp v31, v43, v92 row_ror:8 row_mask:0xf bank_mask:0xf
v_mfma_f32_16x16x32_bf16 v[224:227], v[120:123], v[172:175], v[224:227]
v_cvt_pk_bf16_f32 v28, v28, v29
v_cvt_pk_bf16_f32 v29, v30, v31
s_waitcnt vmcnt(5)
v_mfma_f32_16x16x32_bf16 v[96:99], v[124:127], v[172:175], v[96:99]
ds_write_b32 v6, v28 offset:33824
ds_write_b32 v6, v29 offset:33832
v_mfma_f32_16x16x32_bf16 v[64:67], v[124:127], v[108:111], v[64:67]
v_fmac_f32_dpp v32, v44, v92 row_ror:8 row_mask:0xf bank_mask:0xf
v_fmac_f32_dpp v33, v45, v92 row_ror:8 row_mask:0xf bank_mask:0xf
v_mfma_f32_16x16x32_bf16 v[240:243], v[124:127], v[220:223], v[240:243]
v_fmac_f32_dpp v34, v46, v92 row_ror:8 row_mask:0xf bank_mask:0xf
v_fmac_f32_dpp v35, v47, v92 row_ror:8 row_mask:0xf bank_mask:0xf
s_waitcnt vmcnt(4)
v_mfma_f32_16x16x32_bf16 v[192:195], v[152:155], v[236:239], v[192:195]
v_cvt_pk_bf16_f32 v32, v32, v33
v_cvt_pk_bf16_f32 v33, v34, v35
v_mfma_f32_16x16x32_bf16 v[208:211], v[152:155], v[148:151], v[208:211]
ds_write_b32 v2, v32 offset:33824
ds_write_b32 v2, v33 offset:33832
v_mfma_f32_16x16x32_bf16 v[224:227], v[152:155], v[80:83], v[224:227]
s_waitcnt vmcnt(3)
v_mfma_f32_16x16x32_bf16 v[96:99], v[156:159], v[80:83], v[96:99]
v_mfma_f32_16x16x32_bf16 v[64:67], v[156:159], v[148:151], v[64:67]
v_mfma_f32_16x16x32_bf16 v[240:243], v[156:159], v[236:239], v[240:243]
s_waitcnt vmcnt(2)
v_mfma_f32_16x16x32_bf16 v[192:195], v[184:187], v[252:255], v[192:195]
v_mfma_f32_16x16x32_bf16 v[208:211], v[184:187], v[84:87], v[208:211]
v_mfma_f32_16x16x32_bf16 v[224:227], v[184:187], v[88:91], v[224:227]
s_waitcnt vmcnt(1)
v_mfma_f32_16x16x32_bf16 v[96:99], v[188:191], v[88:91], v[96:99]
v_mfma_f32_16x16x32_bf16 v[64:67], v[188:191], v[84:87], v[64:67]
v_mfma_f32_16x16x32_bf16 v[240:243], v[188:191], v[252:255], v[240:243]
s_waitcnt vmcnt(0)
v_mfma_f32_16x16x32_bf16 v[192:195], v[48:51], v[52:55], v[192:195]
v_mfma_f32_16x16x32_bf16 v[208:211], v[48:51], v[56:59], v[208:211]
v_mfma_f32_16x16x32_bf16 v[224:227], v[48:51], v[60:63], v[224:227]
s_nop 5
v_fmac_f32_dpp v192, v240, v92 row_ror:8 row_mask:0xf bank_mask:0xf
v_fmac_f32_dpp v193, v241, v92 row_ror:8 row_mask:0xf bank_mask:0xf
v_fmac_f32_dpp v194, v242, v92 row_ror:8 row_mask:0xf bank_mask:0xf
v_fmac_f32_dpp v195, v243, v92 row_ror:8 row_mask:0xf bank_mask:0xf
v_cvt_pk_bf16_f32 v192, v192, v193
v_cvt_pk_bf16_f32 v193, v194, v195
ds_write_b32 v2, v192 offset:768
ds_write_b32 v2, v193 offset:776
v_fmac_f32_dpp v208, v64, v92 row_ror:8 row_mask:0xf bank_mask:0xf
v_fmac_f32_dpp v209, v65, v92 row_ror:8 row_mask:0xf bank_mask:0xf
v_fmac_f32_dpp v210, v66, v92 row_ror:8 row_mask:0xf bank_mask:0xf
v_fmac_f32_dpp v211, v67, v92 row_ror:8 row_mask:0xf bank_mask:0xf
v_cvt_pk_bf16_f32 v208, v208, v209
v_cvt_pk_bf16_f32 v209, v210, v211
ds_write_b32 v2, v208 offset:800
ds_write_b32 v2, v209 offset:808
v_fmac_f32_dpp v224, v96, v92 row_ror:8 row_mask:0xf bank_mask:0xf
v_fmac_f32_dpp v225, v97, v92 row_ror:8 row_mask:0xf bank_mask:0xf
v_fmac_f32_dpp v226, v98, v92 row_ror:8 row_mask:0xf bank_mask:0xf
v_fmac_f32_dpp v227, v99, v92 row_ror:8 row_mask:0xf bank_mask:0xf
v_cvt_pk_bf16_f32 v224, v224, v225
v_cvt_pk_bf16_f32 v225, v226, v227
ds_write_b32 v7, v224 offset:768
ds_write_b32 v7, v225 offset:776
s_waitcnt lgkmcnt(0)
s_barrier
ds_read_b64_tr_b16 v[28:29], v196 offset:512
ds_read_b64_tr_b16 v[30:31], v197 offset:1536
ds_read_b64_tr_b16 v[36:37], v198 offset:512
ds_read_b64_tr_b16 v[38:39], v199 offset:1536
ds_read_b64_tr_b16 v[44:45], v212 offset:512
ds_read_b64_tr_b16 v[46:47], v213 offset:1536
s_waitcnt lgkmcnt(4)
v_mfma_f32_16x16x32_bf16 v[200:203], v[28:31], v[16:19], v[200:203]
s_waitcnt lgkmcnt(2)
v_mfma_f32_16x16x32_bf16 v[216:219], v[36:39], v[16:19], v[216:219]
s_waitcnt lgkmcnt(0)
v_mfma_f32_16x16x32_bf16 v[232:235], v[44:47], v[16:19], v[232:235]
ds_read_b64_tr_b16 v[52:53], v196 offset:544
ds_read_b64_tr_b16 v[54:55], v197 offset:1568
ds_read_b64_tr_b16 v[60:61], v198 offset:544
ds_read_b64_tr_b16 v[62:63], v199 offset:1568
ds_read_b64_tr_b16 v[68:69], v212 offset:544
ds_read_b64_tr_b16 v[70:71], v213 offset:1568
v_mfma_f32_16x16x32_bf16 v[248:251], v[28:31], v[20:23], v[248:251]
v_mfma_f32_16x16x32_bf16 v[72:75], v[36:39], v[20:23], v[72:75]
v_exp_f32 v200, v200
v_mfma_f32_16x16x32_bf16 v[128:131], v[44:47], v[20:23], v[128:131]
v_exp_f32 v201, v201
v_exp_f32 v216, v216
v_exp_f32 v217, v217
v_exp_f32 v232, v232
v_exp_f32 v233, v233
v_exp_f32 v202, v202
v_exp_f32 v203, v203
v_pk_fma_f32 v[200:201], v[200:201], s[44:45], s[44:45] clamp
v_exp_f32 v218, v218
v_exp_f32 v219, v219
v_pk_fma_f32 v[216:217], v[216:217], s[44:45], s[44:45] clamp
v_exp_f32 v234, v234
v_exp_f32 v235, v235
v_pk_fma_f32 v[232:233], v[232:233], s[44:45], s[44:45] clamp
v_pk_fma_f32 v[202:203], v[200:201], v[202:203], v[200:201]
v_pk_fma_f32 v[218:219], v[216:217], v[218:219], v[216:217]
v_pk_fma_f32 v[234:235], v[232:233], v[234:235], v[232:233]
v_rcp_f32 v202, v202
v_rcp_f32 v203, v203
v_pk_add_f32 v[200:201], s[46:47], v[200:201] neg_lo:[0,1] neg_hi:[0,1]
v_rcp_f32 v218, v218
v_rcp_f32 v219, v219
v_pk_add_f32 v[216:217], s[46:47], v[216:217] neg_lo:[0,1] neg_hi:[0,1]
v_rcp_f32 v234, v234
v_rcp_f32 v235, v235
v_pk_add_f32 v[232:233], s[46:47], v[232:233] neg_lo:[0,1] neg_hi:[0,1]
v_pk_mul_f32 v[200:201], v[200:201], v[202:203]
v_pk_mul_f32 v[216:217], v[216:217], v[218:219]
v_pk_mul_f32 v[232:233], v[232:233], v[234:235]
v_cvt_pk_bf16_f32 v100, v200, v201
v_cvt_pk_bf16_f32 v101, v216, v217
v_cvt_pk_bf16_f32 v102, v232, v233
ds_bpermute_b32 v100, v246, v100
ds_bpermute_b32 v101, v246, v101
ds_bpermute_b32 v102, v246, v102
v_exp_f32 v248, v248
s_waitcnt lgkmcnt(7)
v_mfma_f32_16x16x32_bf16 v[104:107], v[52:55], v[16:19], v[104:107]
v_exp_f32 v249, v249
s_waitcnt lgkmcnt(5)
v_mfma_f32_16x16x32_bf16 v[168:171], v[60:63], v[16:19], v[168:171]
v_exp_f32 v72, v72
s_waitcnt lgkmcnt(3)
v_mfma_f32_16x16x32_bf16 v[144:147], v[68:71], v[16:19], v[144:147]
v_exp_f32 v73, v73
s_waitcnt lgkmcnt(0)
buffer_store_dwordx3 v[100:102], v244, s[20:23], 0 offen nt
v_add_u32 v244, 18432, v244
v_exp_f32 v128, v128
v_exp_f32 v129, v129
v_exp_f32 v250, v250
v_exp_f32 v251, v251
v_pk_fma_f32 v[248:249], v[248:249], s[44:45], s[44:45] clamp
ds_read_b64_tr_b16 v[76:77], v214 offset:0
ds_read_b64_tr_b16 v[78:79], v215 offset:1024
ds_read_b64_tr_b16 v[80:81], v214 offset:512
ds_read_b64_tr_b16 v[82:83], v215 offset:1536
ds_read_b64_tr_b16 v[84:85], v228 offset:0
ds_read_b64_tr_b16 v[86:87], v229 offset:1024
ds_read_b64_tr_b16 v[88:89], v228 offset:512
ds_read_b64_tr_b16 v[90:91], v229 offset:1536
ds_read_b64_tr_b16 v[92:93], v230 offset:0
ds_read_b64_tr_b16 v[94:95], v231 offset:1024
ds_read_b64_tr_b16 v[96:97], v230 offset:512
ds_read_b64_tr_b16 v[98:99], v231 offset:1536
v_exp_f32 v74, v74
v_exp_f32 v75, v75
v_pk_fma_f32 v[72:73], v[72:73], s[44:45], s[44:45] clamp
v_exp_f32 v130, v130
v_exp_f32 v131, v131
v_pk_fma_f32 v[128:129], v[128:129], s[44:45], s[44:45] clamp
v_pk_fma_f32 v[250:251], v[248:249], v[250:251], v[248:249]
v_pk_fma_f32 v[74:75], v[72:73], v[74:75], v[72:73]
v_pk_fma_f32 v[130:131], v[128:129], v[130:131], v[128:129]
v_rcp_f32 v250, v250
v_rcp_f32 v251, v251
v_pk_add_f32 v[248:249], s[46:47], v[248:249] neg_lo:[0,1] neg_hi:[0,1]
v_rcp_f32 v74, v74
v_rcp_f32 v75, v75
v_pk_add_f32 v[72:73], s[46:47], v[72:73] neg_lo:[0,1] neg_hi:[0,1]
v_rcp_f32 v130, v130
v_rcp_f32 v131, v131
v_pk_add_f32 v[128:129], s[46:47], v[128:129] neg_lo:[0,1] neg_hi:[0,1]
v_pk_mul_f32 v[248:249], v[248:249], v[250:251]
v_pk_mul_f32 v[72:73], v[72:73], v[74:75]
v_pk_mul_f32 v[128:129], v[128:129], v[130:131]
v_cvt_pk_bf16_f32 v108, v248, v249
v_cvt_pk_bf16_f32 v109, v72, v73
v_cvt_pk_bf16_f32 v110, v128, v129
ds_bpermute_b32 v108, v246, v108
ds_bpermute_b32 v109, v246, v109
ds_bpermute_b32 v110, v246, v110
v_exp_f32 v104, v104
v_mfma_f32_16x16x32_bf16 v[160:163], v[52:55], v[20:23], v[160:163]
v_exp_f32 v105, v105
v_mfma_f32_16x16x32_bf16 v[136:139], v[60:63], v[20:23], v[136:139]
v_exp_f32 v168, v168
v_mfma_f32_16x16x32_bf16 v[112:115], v[68:71], v[20:23], v[112:115]
v_exp_f32 v169, v169
s_waitcnt lgkmcnt(0)
buffer_store_dwordx3 v[108:110], v245, s[20:23], 0 offen nt
v_add_u32 v245, 18432, v245
v_exp_f32 v144, v144
v_exp_f32 v145, v145
v_exp_f32 v106, v106
v_exp_f32 v107, v107
v_pk_fma_f32 v[104:105], v[104:105], s[44:45], s[44:45] clamp
v_exp_f32 v170, v170
v_exp_f32 v171, v171
v_pk_fma_f32 v[168:169], v[168:169], s[44:45], s[44:45] clamp
v_exp_f32 v146, v146
v_exp_f32 v147, v147
v_pk_fma_f32 v[144:145], v[144:145], s[44:45], s[44:45] clamp
v_pk_fma_f32 v[106:107], v[104:105], v[106:107], v[104:105]
v_pk_fma_f32 v[170:171], v[168:169], v[170:171], v[168:169]
v_pk_fma_f32 v[146:147], v[144:145], v[146:147], v[144:145]
v_rcp_f32 v106, v106
v_rcp_f32 v107, v107
v_pk_add_f32 v[104:105], s[46:47], v[104:105] neg_lo:[0,1] neg_hi:[0,1]
v_rcp_f32 v170, v170
v_rcp_f32 v171, v171
v_pk_add_f32 v[168:169], s[46:47], v[168:169] neg_lo:[0,1] neg_hi:[0,1]
v_rcp_f32 v146, v146
v_rcp_f32 v147, v147
v_pk_add_f32 v[144:145], s[46:47], v[144:145] neg_lo:[0,1] neg_hi:[0,1]
v_pk_mul_f32 v[104:105], v[104:105], v[106:107]
v_pk_mul_f32 v[168:169], v[168:169], v[170:171]
v_pk_mul_f32 v[144:145], v[144:145], v[146:147]
v_cvt_pk_bf16_f32 v116, v104, v105
v_cvt_pk_bf16_f32 v117, v168, v169
v_cvt_pk_bf16_f32 v118, v144, v145
ds_bpermute_b32 v116, v246, v116
ds_bpermute_b32 v117, v246, v117
ds_bpermute_b32 v118, v246, v118
v_exp_f32 v160, v160
v_mfma_f32_16x16x32_bf16 v[252:255], v[76:79], v[8:11], 0
v_exp_f32 v161, v161
v_mfma_f32_16x16x32_bf16 v[240:243], v[84:87], v[8:11], 0
v_exp_f32 v136, v136
v_mfma_f32_16x16x32_bf16 v[236:239], v[92:95], v[8:11], 0
v_exp_f32 v137, v137
v_mfma_f32_16x16x32_bf16 v[252:255], v[80:83], v[16:19], v[252:255]
s_waitcnt lgkmcnt(0)
buffer_store_dwordx3 v[116:118], v244, s[20:23], 0 offen nt
v_add_u32 v244, 18432, v244
v_exp_f32 v112, v112
v_mfma_f32_16x16x32_bf16 v[240:243], v[88:91], v[16:19], v[240:243]
v_exp_f32 v113, v113
v_mfma_f32_16x16x32_bf16 v[236:239], v[96:99], v[16:19], v[236:239]
v_exp_f32 v162, v162
v_exp_f32 v163, v163
v_pk_fma_f32 v[160:161], v[160:161], s[44:45], s[44:45] clamp
v_exp_f32 v138, v138
v_exp_f32 v139, v139
v_pk_fma_f32 v[136:137], v[136:137], s[44:45], s[44:45] clamp
v_exp_f32 v114, v114
v_exp_f32 v115, v115
v_pk_fma_f32 v[112:113], v[112:113], s[44:45], s[44:45] clamp
v_pk_fma_f32 v[162:163], v[160:161], v[162:163], v[160:161]
v_pk_fma_f32 v[138:139], v[136:137], v[138:139], v[136:137]
v_pk_fma_f32 v[114:115], v[112:113], v[114:115], v[112:113]
v_rcp_f32 v162, v162
v_rcp_f32 v163, v163
v_pk_add_f32 v[160:161], s[46:47], v[160:161] neg_lo:[0,1] neg_hi:[0,1]
v_rcp_f32 v138, v138
v_rcp_f32 v139, v139
v_pk_add_f32 v[136:137], s[46:47], v[136:137] neg_lo:[0,1] neg_hi:[0,1]
v_rcp_f32 v114, v114
v_rcp_f32 v115, v115
v_pk_add_f32 v[112:113], s[46:47], v[112:113] neg_lo:[0,1] neg_hi:[0,1]
v_pk_mul_f32 v[160:161], v[160:161], v[162:163]
v_pk_mul_f32 v[136:137], v[136:137], v[138:139]
v_pk_mul_f32 v[112:113], v[112:113], v[114:115]
v_cvt_pk_bf16_f32 v120, v160, v161
v_cvt_pk_bf16_f32 v121, v136, v137
v_cvt_pk_bf16_f32 v122, v112, v113
ds_bpermute_b32 v120, v246, v120
ds_bpermute_b32 v121, v246, v121
ds_bpermute_b32 v122, v246, v122
v_exp_f32 v252, v252
v_mfma_f32_16x16x32_bf16 v[224:227], v[76:79], v[12:15], 0
v_exp_f32 v253, v253
v_mfma_f32_16x16x32_bf16 v[220:223], v[84:87], v[12:15], 0
v_exp_f32 v240, v240
v_mfma_f32_16x16x32_bf16 v[208:211], v[92:95], v[12:15], 0
v_exp_f32 v241, v241
v_mfma_f32_16x16x32_bf16 v[224:227], v[80:83], v[20:23], v[224:227]
s_waitcnt lgkmcnt(0)
buffer_store_dwordx3 v[120:122], v245, s[20:23], 0 offen
v_add_u32 v245, 18432, v245
v_exp_f32 v236, v236
v_mfma_f32_16x16x32_bf16 v[220:223], v[88:91], v[20:23], v[220:223]
v_exp_f32 v237, v237
v_mfma_f32_16x16x32_bf16 v[208:211], v[96:99], v[20:23], v[208:211]
v_exp_f32 v254, v254
v_exp_f32 v255, v255
v_pk_fma_f32 v[252:253], v[252:253], s[44:45], s[44:45] clamp
v_exp_f32 v242, v242
v_exp_f32 v243, v243
v_pk_fma_f32 v[240:241], v[240:241], s[44:45], s[44:45] clamp
v_exp_f32 v238, v238
v_exp_f32 v239, v239
v_pk_fma_f32 v[236:237], v[236:237], s[44:45], s[44:45] clamp
v_pk_fma_f32 v[254:255], v[252:253], v[254:255], v[252:253]
v_pk_fma_f32 v[242:243], v[240:241], v[242:243], v[240:241]
v_pk_fma_f32 v[238:239], v[236:237], v[238:239], v[236:237]
v_rcp_f32 v254, v254
v_rcp_f32 v255, v255
v_pk_add_f32 v[252:253], s[46:47], v[252:253] neg_lo:[0,1] neg_hi:[0,1]
v_rcp_f32 v242, v242
v_rcp_f32 v243, v243
v_pk_add_f32 v[240:241], s[46:47], v[240:241] neg_lo:[0,1] neg_hi:[0,1]
v_rcp_f32 v238, v238
v_rcp_f32 v239, v239
v_pk_add_f32 v[236:237], s[46:47], v[236:237] neg_lo:[0,1] neg_hi:[0,1]
v_pk_mul_f32 v[252:253], v[252:253], v[254:255]
v_pk_mul_f32 v[240:241], v[240:241], v[242:243]
v_pk_mul_f32 v[236:237], v[236:237], v[238:239]
v_cvt_pk_bf16_f32 v124, v252, v253
v_cvt_pk_bf16_f32 v125, v240, v241
v_cvt_pk_bf16_f32 v126, v236, v237
ds_bpermute_b32 v124, v246, v124
ds_bpermute_b32 v125, v246, v125
ds_bpermute_b32 v126, v246, v126
v_exp_f32 v224, v224
v_exp_f32 v225, v225
v_exp_f32 v220, v220
v_exp_f32 v221, v221
s_waitcnt lgkmcnt(0)
buffer_store_dwordx3 v[124:126], v244, s[20:23], 0 offen
v_exp_f32 v208, v208
v_exp_f32 v209, v209
v_exp_f32 v226, v226
v_exp_f32 v227, v227
v_pk_fma_f32 v[224:225], v[224:225], s[44:45], s[44:45] clamp
v_exp_f32 v222, v222
v_exp_f32 v223, v223
v_pk_fma_f32 v[220:221], v[220:221], s[44:45], s[44:45] clamp
v_exp_f32 v210, v210
v_exp_f32 v211, v211
v_pk_fma_f32 v[208:209], v[208:209], s[44:45], s[44:45] clamp
v_pk_fma_f32 v[226:227], v[224:225], v[226:227], v[224:225]
v_pk_fma_f32 v[222:223], v[220:221], v[222:223], v[220:221]
v_pk_fma_f32 v[210:211], v[208:209], v[210:211], v[208:209]
v_rcp_f32 v226, v226
v_rcp_f32 v227, v227
v_pk_add_f32 v[224:225], s[46:47], v[224:225] neg_lo:[0,1] neg_hi:[0,1]
v_rcp_f32 v222, v222
v_rcp_f32 v223, v223
v_pk_add_f32 v[220:221], s[46:47], v[220:221] neg_lo:[0,1] neg_hi:[0,1]
v_rcp_f32 v210, v210
v_rcp_f32 v211, v211
v_pk_add_f32 v[208:209], s[46:47], v[208:209] neg_lo:[0,1] neg_hi:[0,1]
v_pk_mul_f32 v[224:225], v[224:225], v[226:227]
v_pk_mul_f32 v[220:221], v[220:221], v[222:223]
v_pk_mul_f32 v[208:209], v[208:209], v[210:211]
v_cvt_pk_bf16_f32 v132, v224, v225
v_cvt_pk_bf16_f32 v133, v220, v221
v_cvt_pk_bf16_f32 v134, v208, v209
ds_bpermute_b32 v132, v246, v132
ds_bpermute_b32 v133, v246, v133
ds_bpermute_b32 v134, v246, v134
s_waitcnt lgkmcnt(0)
buffer_store_dwordx3 v[132:134], v245, s[20:23], 0 offen
L_done:
s_endpgm
L_spare:
s_cmp_lg_u32 s2, 6
s_cbranch_scc1 L_done
s_cmp_lg_u32 s3, 0
s_cbranch_scc1 L_done
v_mul_u32_u24 v1, 128, v0
v_add_u32 v1, 5308416, v1
v_mov_b32 v4, 0
v_mov_b32 v5, 0
v_mov_b32 v6, 0
v_mov_b32 v7, 1
s_mov_b32 s14, 5315328
s_mov_b32 s15, 0x20000
s_mov_b32 s26, 4
s_mov_b32 s27, 0x20000
s_waitcnt lgkmcnt(0)
s_mov_b64 s[24:25], s[22:23]
buffer_store_dwordx3 v[4:6], v1, s[12:15], 0 offen sc1
v_lshlrev_b32 v2, 2, v0
s_waitcnt vmcnt(0)
buffer_store_dword v7, v2, s[24:27], 0 offen sc1
s_endpgm
.section .rodata,"a"
.p2align 6
.amdhsa_kernel standalone__autoregressive_conv_wavernn__speech_kernel
  .amdhsa_next_free_vgpr 256
  .amdhsa_next_free_sgpr 102
  .amdhsa_accum_offset 256
  .amdhsa_group_segment_fixed_size 0
  .amdhsa_kernarg_size 40
  .amdhsa_user_sgpr_count 2
  .amdhsa_user_sgpr_kernarg_segment_ptr 1
  .amdhsa_system_sgpr_workgroup_id_x 1
.end_amdhsa_kernel
```
